```python
import torch

def _softmax(x, axis=-1):
    return torch.softmax(x, dim=axis)
def _gelu(x):
    return torch.nn.functional.gelu(x, approximate="tanh")
def _silu(x):
    return torch.nn.functional.silu(x)
def _sigmoid(x):
    return torch.sigmoid(x)
def _layernorm(x, axis=-1, eps=1e-5):
    m = x.mean(dim=axis, keepdim=True)
    v = x.var(dim=axis, keepdim=True, unbiased=False)
    return (x - m) / torch.sqrt(v + eps)
def _scatter_add(tgt, idx, src, axis=0):
    return tgt.clone().index_add_(axis, idx, src)
def _segment_sum(src, seg, n):
    out = torch.zeros((n,) + src.shape[1:], dtype=src.dtype)
    return out.index_add_(0, seg, src)
def _pad(x, pw):
    flat = tuple(v for pair in reversed(pw) for v in pair)
    return torch.nn.functional.pad(x, flat)

kernel_name = 'recurrent_scan__sliding_block_cached__swiglu_ffn__decode'

def setup_inputs():

    _w = (lambda a: (lambda t: t.to(torch.bfloat16) if t.is_floating_point() else t)(torch.as_tensor(a)))
    def _A_setup():
        B, Sq, D = 1, 1, 512
        Hq, Hkv, Sk, Dh = 32, 8, 16384, 128
        assert Hq % Hkv == 0, (Hq, Hkv)
        return {
            "x": _w((lambda *s: torch.randn(*s, dtype=torch.bfloat16) * 0.05)(B, Sq, D)),
            "k_cache": _w((lambda *s: torch.randn(*s, dtype=torch.bfloat16) * 1.6)(B, Hkv, Sk, Dh)),
            "v_cache": _w((lambda *s: torch.randn(*s, dtype=torch.bfloat16) * 0.2)(B, Hkv, Sk, Dh)),
            "wq": _w((lambda *s: torch.randn(*s, dtype=torch.bfloat16) * 1.6)(D, Hq * Dh) * (D ** -0.5)),
            "wo": _w((lambda *s: torch.randn(*s, dtype=torch.bfloat16) * 0.2)(Hq * Dh, D) * ((Hq * Dh) ** -0.5)),
        }
    _A_in = _A_setup()

    def _B_setup():
        B, S, D, F = 1, 1, 512, 1792
        return {
            "x": _w((lambda *s: torch.randn(*s, dtype=torch.bfloat16) * 0.05)(B, S, D)),
            "w_gate": _w((lambda *s: torch.randn(*s, dtype=torch.bfloat16) * 0.1)(D, F)),
            "w_up": _w((lambda *s: torch.randn(*s, dtype=torch.bfloat16) * 0.1)(D, F)),
            "w_down": _w((lambda *s: torch.randn(*s, dtype=torch.bfloat16) * 0.1)(F, D)),
        }
    _B_in = _B_setup()

    return {
        "A_x": _A_in["x"],
        "A_k_cache": _A_in["k_cache"],
        "A_v_cache": _A_in["v_cache"],
        "A_wq": _A_in["wq"],
        "A_wo": _A_in["wo"],
        "B_x": _B_in["x"],
        "B_w_gate": _B_in["w_gate"],
        "B_w_up": _B_in["w_up"],
        "B_w_down": _B_in["w_down"],
    }

def reference(A_x, A_k_cache, A_v_cache, A_wq, A_wo, B_x, B_w_gate, B_w_up, B_w_down):
    def _A_ref(x, k_cache, v_cache, wq, wo):
        B, Sq, D = x.shape
        Hq, Dh = 32, 128
        Hkv, Sk = k_cache.shape[1], k_cache.shape[2]
        W = min(4096, max(256, Sk // 4))
        rep = Hq // Hkv
        q = (lambda x, *d: x.permute(*d))((x @ wq).reshape(B, Sq, Hq, Dh), 0, 2, 1, 3)
        k = (lambda x, n, axis: torch.repeat_interleave(x, n, dim=axis))(k_cache[:, :, Sk - W:, :], rep, axis=1)
        v = (lambda x, n, axis: torch.repeat_interleave(x, n, dim=axis))(v_cache[:, :, Sk - W:, :], rep, axis=1)
        scores = torch.einsum("bhqd,bhkd->bhqk", q, k) * (Dh ** -0.5)
        p = _softmax(scores, axis=-1)
        o = torch.einsum("bhqk,bhkd->bhqd", p, v)
        return (lambda x, *d: x.permute(*d))(o, 0, 2, 1, 3).reshape(B, Sq, Hq * Dh) @ wo

    def _B_ref(x, w_gate, w_up, w_down):
        g = _silu(x @ w_gate)
        u = x @ w_up
        return (g * u) @ w_down

    x = A_x
    xn = _layernorm(x, axis=-1)
    s = _A_ref(xn, A_k_cache, A_v_cache, A_wq, A_wo)
    g = _silu(_B_ref(xn, B_w_gate, B_w_up, B_w_down))
    return x + s * g
```

```asm
; @launch grid=(256,1,1) block=(448,1,1) lds=131072
.amdgcn_target "amdgcn-amd-amdhsa--gfx950"
.text
.globl recurrent_scan__sliding_block_cached__swiglu_ffn__decode_kernel
.p2align 8
.type recurrent_scan__sliding_block_cached__swiglu_ffn__decode_kernel,@function
recurrent_scan__sliding_block_cached__swiglu_ffn__decode_kernel:
  s_load_dwordx16 s[4:19], s[0:1], 0
  s_load_dwordx8 s[20:27], s[0:1], 64
  v_lshrrev_b32 v2, 6, v0
  v_lshrrev_b32 v4, 3, v0
  s_cmpk_ge_u32 s2, 256
  v_readfirstlane_b32 s28, v2
  s_cbranch_scc1 L_end
  s_and_b32 s29, s2, 7
  v_and_b32 v1, 63, v0
  s_cmp_ge_u32 s28, 4
  s_cbranch_scc1 L_nw
  s_getpc_b64 s[36:37]
  v_lshlrev_b32 v2, 6, v0
  v_min_u32 v2, L_codeend-recurrent_scan__sliding_block_cached__swiglu_ffn__decode_kernel-0x80, v2
  global_load_dword v112, v2, s[36:37]
  v_and_b32 v7, 7, v0
  v_and_b32 v12, 6, v4
  v_xor_b32 v7, v7, v12
  v_lshlrev_b32 v7, 4, v7
  v_lshl_add_u32 v4, v4, 13, v7
  s_lshr_b32 s31, s2, 6
  s_lshl_b32 s31, s31, 20
  s_lshl_b32 s34, s29, 10
  s_or_b32 s31, s31, s34
  s_lshl_b32 s34, s2, 4
  s_and_b32 s34, s34, 0x380
  s_or_b32 s31, s31, s34
  s_lshl_b32 m0, s28, 12
  v_lshlrev_b32 v3, 4, v1
  s_setprio 3
  s_waitcnt lgkmcnt(0)
  global_load_dwordx4 v[8:11], v3, s[4:5]
  s_add_u32 s32, s10, s31
  s_addc_u32 s33, s11, 0
  global_load_lds_dwordx4 v4, s[32:33] offset:0 nt
  v_add_u32 v4, 261120, v4
  global_load_lds_dwordx4 v4, s[32:33] offset:1024 nt
  v_add_u32 v4, 261120, v4
  global_load_lds_dwordx4 v4, s[32:33] offset:2048 nt
  v_add_u32 v4, 261120, v4
  global_load_lds_dwordx4 v4, s[32:33] offset:3072 nt
  s_load_dword s3, s[26:27], 0
  s_barrier
  s_branch L_w2
.p2align 8
L_nw:
  v_lshrrev_b32 v5, 4, v1
  v_and_b32 v6, 15, v1
  s_cmp_eq_u32 s28, 6
  s_cbranch_scc1 L_loader
L_fstart:
  v_lshlrev_b32 v3, 4, v1
  v_add_u32 v16, 130048, v3
  v_mov_b32 v8, 0
  v_mov_b32 v9, 0
  v_mov_b32 v10, 0
  v_mov_b32 v11, 0
  v_mov_b32 v17, 0xff800000
  v_lshlrev_b32 v18, 2, v1
  v_add_u32 v18, 0x10000, v18
  s_mov_b64 exec, 15
  ds_write_b128 v16, v[8:11]
  ds_write_b32 v18, v17 offset:63744
  s_mov_b64 exec, -1
  s_waitcnt lgkmcnt(0)
  global_load_dwordx4 v[8:11], v3, s[4:5]
  s_load_dword s3, s[26:27], 0
  s_barrier
  s_branch L_f2
L_loader:
  s_setprio 3
  s_lshr_b32 s30, s2, 3
  v_xor_b32 v8, v5, v6
  v_lshlrev_b32 v8, 4, v8
  v_lshl_add_u32 v8, v5, 8, v8
  v_xor_b32 v9, 64, v8
  v_xor_b32 v10, 0x80, v8
  v_xor_b32 v11, 0xc0, v8
  s_lshl_b32 s53, s29, 22
  s_lshl_b32 s34, s30, 15
  s_add_u32 s53, s53, s34
  s_add_u32 s53, s53, 0x300000
  s_add_u32 s50, s30, s29
  s_lshr_b32 s31, s2, 6
  s_bfe_u32 s34, s2, 0x30003
  s_mul_i32 s30, s31, 7
  s_add_u32 s30, s30, s34
  s_cmp_gt_u32 s34, 3
  s_subb_u32 s30, s30, 0
  s_add_u32 s31, s31, 28
  s_cmp_eq_u32 s34, 3
  s_cselect_b32 s30, s31, s30
  s_and_b32 s52, s30, 24
  s_and_b32 s93, s30, 7
  s_and_b32 s31, s29, 3
  s_and_b32 s34, s29, 4
  s_cmp_ge_u32 s30, 24
  s_cselect_b32 s31, s31, s29
  s_cselect_b32 s34, s34, 0
  s_cselect_b32 s91, 1048576, 0
  s_add_u32 s52, s52, s31
  s_add_u32 s93, s93, s34
  v_lshrrev_b32 v4, 3, v1
  v_and_b32 v7, 7, v1
  v_and_b32 v12, 6, v4
  v_xor_b32 v7, v7, v12
  v_mul_u32_u24 v18, 3584, v4
  v_lshl_add_u32 v18, v7, 4, v18
  v_add_u32 v19, 27648, v18
  v_add_u32 v20, 55296, v18
  v_add_u32 v21, 82944, v18
  s_and_b32 s34, s30, 3
  s_lshl_b32 s46, s34, 8
  s_mul_i32 s47, s34, 458752
  s_lshl_b32 s48, s52, 7
  s_add_u32 s47, s47, s48
  s_lshr_b32 s49, s93, 2
  s_waitcnt lgkmcnt(0)
  s_add_u32 s32, s6, s53
  s_addc_u32 s33, s7, 0
  s_cmp_lg_u32 s49, 0
  s_cselect_b32 s44, s18, s16
  s_cselect_b32 s45, s19, s17
  s_add_u32 s44, s44, s47
  s_addc_u32 s45, s45, 0
  v_mov_b32 v127, 130048
  v_mov_b32 v126, 1
  s_mov_b32 s59, 0x800000
  v_lshlrev_b32 v14, 1, v5
  v_xor_b32 v14, v14, v6
  v_lshlrev_b32 v14, 4, v14
  v_lshl_add_u32 v12, v5, 8, v14
  v_xor_b32 v13, 0x80, v12
  v_lshl_add_u32 v14, v5, 10, v14
  v_xor_b32 v15, 0x80, v14
  v_add_u32 v15, 3072, v15
  v_add_u32 v16, 6144, v14
  v_add_u32 v17, 6144, v15
  s_lshl_b32 s35, s29, 19
  s_lshr_b32 s34, s30, 2
  s_add_u32 s51, s34, s29
  s_lshl_b32 s34, s34, 16
  s_add_u32 s35, s35, s34
  s_add_u32 s35, s35, s46
  s_lshl_b32 s48, s52, 1
  s_add_u32 s48, s48, s49
  s_lshl_b32 s48, s48, 15
  s_add_u32 s48, s48, s46
  s_add_u32 s38, s8, s53
  s_addc_u32 s39, s9, 0
  s_add_u32 s40, s12, s35
  s_addc_u32 s41, s13, 0
  s_add_u32 s42, s20, s48
  s_addc_u32 s43, s21, 0
  s_barrier
  s_cmp_ge_u32 s30, 28
  s_cbranch_scc1 L_lite
  s_add_u32 s34, s50, 0
  s_and_b32 s34, s34, 3
  s_mul_i32 s35, s34, 114688
  s_lshl_b32 s34, s34, 12
  s_add_u32 m0, s34, 16384
  s_add_u32 s36, s44, s35
  s_addc_u32 s37, s45, 0
  global_load_lds_dwordx4 v18, s[36:37] offset:0 nt
  global_load_lds_dwordx4 v19, s[36:37] offset:1024 nt
  global_load_lds_dwordx4 v20, s[36:37] offset:2048 nt
  global_load_lds_dwordx4 v21, s[36:37] offset:3072 nt
  s_add_u32 s34, s50, 1
  s_and_b32 s34, s34, 3
  s_mul_i32 s35, s34, 114688
  s_lshl_b32 s34, s34, 12
  s_add_u32 m0, s34, 16384
  s_add_u32 s36, s44, s35
  s_addc_u32 s37, s45, 0
  global_load_lds_dwordx4 v18, s[36:37] offset:0 nt
  global_load_lds_dwordx4 v19, s[36:37] offset:1024 nt
  global_load_lds_dwordx4 v20, s[36:37] offset:2048 nt
  global_load_lds_dwordx4 v21, s[36:37] offset:3072 nt
  s_add_u32 s34, s50, 2
  s_and_b32 s34, s34, 3
  s_mul_i32 s35, s34, 114688
  s_lshl_b32 s34, s34, 12
  s_add_u32 m0, s34, 16384
  s_add_u32 s36, s44, s35
  s_addc_u32 s37, s45, 0
  global_load_lds_dwordx4 v18, s[36:37] offset:0 nt
  global_load_lds_dwordx4 v19, s[36:37] offset:1024 nt
  global_load_lds_dwordx4 v20, s[36:37] offset:2048 nt
  global_load_lds_dwordx4 v21, s[36:37] offset:3072 nt
  s_add_u32 s34, s50, 3
  s_and_b32 s34, s34, 3
  s_mul_i32 s35, s34, 114688
  s_lshl_b32 s34, s34, 12
  s_add_u32 m0, s34, 16384
  s_add_u32 s36, s44, s35
  s_addc_u32 s37, s45, 0
  global_load_lds_dwordx4 v18, s[36:37] offset:0 nt
  global_load_lds_dwordx4 v19, s[36:37] offset:1024 nt
  global_load_lds_dwordx4 v20, s[36:37] offset:2048 nt
  global_load_lds_dwordx4 v21, s[36:37] offset:3072 nt
  s_add_u32 s34, s50, 0
  s_and_b32 s34, s34, 7
  s_lshl_b32 s35, s34, 12
  s_mov_b32 m0, 32768
  s_add_u32 s36, s32, s35
  s_addc_u32 s37, s33, 0
  global_load_lds_dwordx4 v8, s[36:37] offset:0 nt
  global_load_lds_dwordx4 v9, s[36:37] offset:1024 nt
  global_load_lds_dwordx4 v10, s[36:37] offset:2048 nt
  global_load_lds_dwordx4 v11, s[36:37] offset:3072 nt
  s_add_u32 s34, s50, 1
  s_and_b32 s34, s34, 7
  s_lshl_b32 s35, s34, 12
  s_mov_b32 m0, 36864
  s_add_u32 s36, s32, s35
  s_addc_u32 s37, s33, 0
  global_load_lds_dwordx4 v8, s[36:37] offset:0 nt
  global_load_lds_dwordx4 v9, s[36:37] offset:1024 nt
  global_load_lds_dwordx4 v10, s[36:37] offset:2048 nt
  global_load_lds_dwordx4 v11, s[36:37] offset:3072 nt
  s_add_u32 s34, s50, 2
  s_and_b32 s34, s34, 7
  s_lshl_b32 s35, s34, 12
  s_mov_b32 m0, 40960
  s_add_u32 s36, s32, s35
  s_addc_u32 s37, s33, 0
  global_load_lds_dwordx4 v8, s[36:37] offset:0 nt
  global_load_lds_dwordx4 v9, s[36:37] offset:1024 nt
  global_load_lds_dwordx4 v10, s[36:37] offset:2048 nt
  global_load_lds_dwordx4 v11, s[36:37] offset:3072 nt
  s_waitcnt vmcnt(24)
  s_add_u32 s34, s50, 3
  s_and_b32 s34, s34, 7
  s_lshl_b32 s35, s34, 12
  s_mov_b32 m0, 45056
  s_add_u32 s36, s32, s35
  s_addc_u32 s37, s33, 0
  global_load_lds_dwordx4 v8, s[36:37] offset:0 nt
  global_load_lds_dwordx4 v9, s[36:37] offset:1024 nt
  global_load_lds_dwordx4 v10, s[36:37] offset:2048 nt
  global_load_lds_dwordx4 v11, s[36:37] offset:3072 nt
  s_waitcnt vmcnt(24)
  s_add_u32 s34, s50, 4
  s_and_b32 s34, s34, 7
  s_lshl_b32 s35, s34, 12
  s_mov_b32 m0, 49152
  s_add_u32 s36, s32, s35
  s_addc_u32 s37, s33, 0
  global_load_lds_dwordx4 v8, s[36:37] offset:0 nt
  global_load_lds_dwordx4 v9, s[36:37] offset:1024 nt
  global_load_lds_dwordx4 v10, s[36:37] offset:2048 nt
  global_load_lds_dwordx4 v11, s[36:37] offset:3072 nt
  s_waitcnt vmcnt(24)
  s_add_u32 s34, s50, 5
  s_and_b32 s34, s34, 7
  s_lshl_b32 s35, s34, 12
  s_mov_b32 m0, 53248
  s_add_u32 s36, s32, s35
  s_addc_u32 s37, s33, 0
  global_load_lds_dwordx4 v8, s[36:37] offset:0 nt
  global_load_lds_dwordx4 v9, s[36:37] offset:1024 nt
  global_load_lds_dwordx4 v10, s[36:37] offset:2048 nt
  global_load_lds_dwordx4 v11, s[36:37] offset:3072 nt
  s_waitcnt vmcnt(24)
  v_mov_b32 v126, 4
  ds_write_b8 v127, v126 offset:20
  s_add_u32 s34, s50, 6
  s_and_b32 s34, s34, 7
  s_lshl_b32 s35, s34, 12
  s_mov_b32 m0, 57344
  s_add_u32 s36, s32, s35
  s_addc_u32 s37, s33, 0
  global_load_lds_dwordx4 v8, s[36:37] offset:0 nt
  global_load_lds_dwordx4 v9, s[36:37] offset:1024 nt
  global_load_lds_dwordx4 v10, s[36:37] offset:2048 nt
  global_load_lds_dwordx4 v11, s[36:37] offset:3072 nt
  s_waitcnt vmcnt(24)
  s_add_u32 s34, s50, 7
  s_and_b32 s34, s34, 7
  s_lshl_b32 s35, s34, 12
  s_mov_b32 m0, 61440
  s_add_u32 s36, s32, s35
  s_addc_u32 s37, s33, 0
  global_load_lds_dwordx4 v8, s[36:37] offset:0 nt
  global_load_lds_dwordx4 v9, s[36:37] offset:1024 nt
  global_load_lds_dwordx4 v10, s[36:37] offset:2048 nt
  global_load_lds_dwordx4 v11, s[36:37] offset:3072 nt
  s_waitcnt vmcnt(24)
  s_add_u32 s34, s50, 0
  s_and_b32 s34, s34, 7
  s_lshl_b32 s35, s34, 12
  s_mov_b32 m0, 65536
  s_add_u32 s36, s38, s35
  s_addc_u32 s37, s39, 0
  global_load_lds_dwordx4 v12, s[36:37] offset:0 nt
  global_load_lds_dwordx4 v13, s[36:37] offset:1024 nt
  global_load_lds_dwordx4 v12, s[36:37] offset:2048 nt
  global_load_lds_dwordx4 v13, s[36:37] offset:3072 nt
  s_waitcnt vmcnt(24)
  v_mov_b32 v126, 7
  ds_write_b8 v127, v126 offset:20
  s_add_u32 s34, s50, 1
  s_and_b32 s34, s34, 7
  s_lshl_b32 s35, s34, 12
  s_mov_b32 m0, 69632
  s_add_u32 s36, s38, s35
  s_addc_u32 s37, s39, 0
  global_load_lds_dwordx4 v12, s[36:37] offset:0 nt
  global_load_lds_dwordx4 v13, s[36:37] offset:1024 nt
  global_load_lds_dwordx4 v12, s[36:37] offset:2048 nt
  global_load_lds_dwordx4 v13, s[36:37] offset:3072 nt
  s_waitcnt vmcnt(24)
  s_add_u32 s34, s50, 2
  s_and_b32 s34, s34, 7
  s_lshl_b32 s35, s34, 12
  s_mov_b32 m0, 73728
  s_add_u32 s36, s38, s35
  s_addc_u32 s37, s39, 0
  global_load_lds_dwordx4 v12, s[36:37] offset:0 nt
  global_load_lds_dwordx4 v13, s[36:37] offset:1024 nt
  global_load_lds_dwordx4 v12, s[36:37] offset:2048 nt
  global_load_lds_dwordx4 v13, s[36:37] offset:3072 nt
  s_waitcnt vmcnt(24)
  s_add_u32 s34, s50, 3
  s_and_b32 s34, s34, 7
  s_lshl_b32 s35, s34, 12
  s_mov_b32 m0, 77824
  s_add_u32 s36, s38, s35
  s_addc_u32 s37, s39, 0
  global_load_lds_dwordx4 v12, s[36:37] offset:0 nt
  global_load_lds_dwordx4 v13, s[36:37] offset:1024 nt
  global_load_lds_dwordx4 v12, s[36:37] offset:2048 nt
  global_load_lds_dwordx4 v13, s[36:37] offset:3072 nt
  s_waitcnt vmcnt(24)
  v_mov_b32 v126, 10
  ds_write_b8 v127, v126 offset:20
  s_add_u32 s34, s50, 4
  s_and_b32 s34, s34, 7
  s_lshl_b32 s35, s34, 12
  s_mov_b32 m0, 81920
  s_add_u32 s36, s38, s35
  s_addc_u32 s37, s39, 0
  global_load_lds_dwordx4 v12, s[36:37] offset:0 nt
  global_load_lds_dwordx4 v13, s[36:37] offset:1024 nt
  global_load_lds_dwordx4 v12, s[36:37] offset:2048 nt
  global_load_lds_dwordx4 v13, s[36:37] offset:3072 nt
  s_waitcnt vmcnt(24)
  v_mov_b32 v126, 11
  ds_write_b8 v127, v126 offset:20
  s_add_u32 s34, s50, 5
  s_and_b32 s34, s34, 7
  s_lshl_b32 s35, s34, 12
  s_mov_b32 m0, 86016
  s_add_u32 s36, s38, s35
  s_addc_u32 s37, s39, 0
  global_load_lds_dwordx4 v12, s[36:37] offset:0 nt
  global_load_lds_dwordx4 v13, s[36:37] offset:1024 nt
  global_load_lds_dwordx4 v12, s[36:37] offset:2048 nt
  global_load_lds_dwordx4 v13, s[36:37] offset:3072 nt
  s_waitcnt vmcnt(24)
  v_mov_b32 v126, 12
  ds_write_b8 v127, v126 offset:20
  s_add_u32 s34, s50, 6
  s_and_b32 s34, s34, 7
  s_lshl_b32 s35, s34, 12
  s_mov_b32 m0, 90112
  s_add_u32 s36, s38, s35
  s_addc_u32 s37, s39, 0
  global_load_lds_dwordx4 v12, s[36:37] offset:0 nt
  global_load_lds_dwordx4 v13, s[36:37] offset:1024 nt
  global_load_lds_dwordx4 v12, s[36:37] offset:2048 nt
  global_load_lds_dwordx4 v13, s[36:37] offset:3072 nt
  s_waitcnt vmcnt(24)
  v_mov_b32 v126, 13
  ds_write_b8 v127, v126 offset:20
  s_add_u32 s34, s50, 7
  s_and_b32 s34, s34, 7
  s_lshl_b32 s35, s34, 12
  s_mov_b32 m0, 94208
  s_add_u32 s36, s38, s35
  s_addc_u32 s37, s39, 0
  global_load_lds_dwordx4 v12, s[36:37] offset:0 nt
  global_load_lds_dwordx4 v13, s[36:37] offset:1024 nt
  global_load_lds_dwordx4 v12, s[36:37] offset:2048 nt
  global_load_lds_dwordx4 v13, s[36:37] offset:3072 nt
  s_waitcnt vmcnt(24)
  v_mov_b32 v126, 14
  ds_write_b8 v127, v126 offset:20
  s_add_u32 s34, s51, 0
  s_and_b32 s34, s34, 3
  s_mul_i32 s35, s34, 16384
  s_lshl_b32 s34, s34, 12
  s_add_u32 m0, s34, 98304
  s_add_u32 s36, s40, s35
  s_addc_u32 s37, s41, 0
  global_load_lds_dwordx4 v14, s[36:37] offset:0 nt
  global_load_lds_dwordx4 v15, s[36:37] offset:1024 nt
  global_load_lds_dwordx4 v16, s[36:37] offset:2048 nt
  global_load_lds_dwordx4 v17, s[36:37] offset:3072 nt
  s_waitcnt vmcnt(24)
  s_add_u32 s34, s51, 1
  s_and_b32 s34, s34, 3
  s_mul_i32 s35, s34, 16384
  s_lshl_b32 s34, s34, 12
  s_add_u32 m0, s34, 98304
  s_add_u32 s36, s40, s35
  s_addc_u32 s37, s41, 0
  global_load_lds_dwordx4 v14, s[36:37] offset:0 nt
  global_load_lds_dwordx4 v15, s[36:37] offset:1024 nt
  global_load_lds_dwordx4 v16, s[36:37] offset:2048 nt
  global_load_lds_dwordx4 v17, s[36:37] offset:3072 nt
  s_waitcnt vmcnt(24)
  v_mov_b32 v126, 16
  ds_write_b8 v127, v126 offset:20
  s_add_u32 s34, s51, 2
  s_and_b32 s34, s34, 3
  s_mul_i32 s35, s34, 16384
  s_lshl_b32 s34, s34, 12
  s_add_u32 m0, s34, 98304
  s_add_u32 s36, s40, s35
  s_addc_u32 s37, s41, 0
  global_load_lds_dwordx4 v14, s[36:37] offset:0 nt
  global_load_lds_dwordx4 v15, s[36:37] offset:1024 nt
  global_load_lds_dwordx4 v16, s[36:37] offset:2048 nt
  global_load_lds_dwordx4 v17, s[36:37] offset:3072 nt
  s_waitcnt vmcnt(24)
  s_add_u32 s34, s51, 3
  s_and_b32 s34, s34, 3
  s_mul_i32 s35, s34, 16384
  s_lshl_b32 s34, s34, 12
  s_add_u32 m0, s34, 98304
  s_add_u32 s36, s40, s35
  s_addc_u32 s37, s41, 0
  global_load_lds_dwordx4 v14, s[36:37] offset:0 nt
  global_load_lds_dwordx4 v15, s[36:37] offset:1024 nt
  global_load_lds_dwordx4 v16, s[36:37] offset:2048 nt
  global_load_lds_dwordx4 v17, s[36:37] offset:3072 nt
  s_waitcnt vmcnt(24)
  v_mov_b32 v126, 18
  ds_write_b8 v127, v126 offset:20
  s_add_u32 s34, s51, 0
  s_and_b32 s34, s34, 1
  s_mul_i32 s35, s34, 16384
  s_lshl_b32 s34, s34, 12
  s_add_u32 m0, s34, 114688
  s_add_u32 s36, s42, s35
  s_addc_u32 s37, s43, 0
  global_load_lds_dwordx4 v14, s[36:37] offset:0 nt
  global_load_lds_dwordx4 v15, s[36:37] offset:1024 nt
  global_load_lds_dwordx4 v16, s[36:37] offset:2048 nt
  global_load_lds_dwordx4 v17, s[36:37] offset:3072 nt
  s_waitcnt vmcnt(24)
  s_add_u32 s34, s51, 1
  s_and_b32 s34, s34, 1
  s_mul_i32 s35, s34, 16384
  s_lshl_b32 s34, s34, 12
  s_add_u32 m0, s34, 114688
  s_add_u32 s36, s42, s35
  s_addc_u32 s37, s43, 0
  global_load_lds_dwordx4 v14, s[36:37] offset:0 nt
  global_load_lds_dwordx4 v15, s[36:37] offset:1024 nt
  global_load_lds_dwordx4 v16, s[36:37] offset:2048 nt
  global_load_lds_dwordx4 v17, s[36:37] offset:3072 nt
  v_mov_b32 v126, 20
  s_waitcnt vmcnt(24)
  ds_write_b8 v127, v126 offset:20
  v_mov_b32 v126, 24
  s_waitcnt vmcnt(8)
  ds_write_b8 v127, v126 offset:20
  v_mov_b32 v126, 26
  s_waitcnt vmcnt(0)
  ds_write_b8 v127, v126 offset:20
  s_endpgm
L_lite:
  s_add_u32 s34, s50, 0
  s_and_b32 s34, s34, 7
  s_lshl_b32 s35, s34, 12
  s_mov_b32 m0, 32768
  s_add_u32 s36, s32, s35
  s_addc_u32 s37, s33, 0
  global_load_lds_dwordx4 v8, s[36:37] offset:0 nt
  global_load_lds_dwordx4 v9, s[36:37] offset:1024 nt
  global_load_lds_dwordx4 v10, s[36:37] offset:2048 nt
  global_load_lds_dwordx4 v11, s[36:37] offset:3072 nt
  s_add_u32 s34, s50, 1
  s_and_b32 s34, s34, 7
  s_lshl_b32 s35, s34, 12
  s_mov_b32 m0, 36864
  s_add_u32 s36, s32, s35
  s_addc_u32 s37, s33, 0
  global_load_lds_dwordx4 v8, s[36:37] offset:0 nt
  global_load_lds_dwordx4 v9, s[36:37] offset:1024 nt
  global_load_lds_dwordx4 v10, s[36:37] offset:2048 nt
  global_load_lds_dwordx4 v11, s[36:37] offset:3072 nt
  s_add_u32 s34, s50, 2
  s_and_b32 s34, s34, 7
  s_lshl_b32 s35, s34, 12
  s_mov_b32 m0, 40960
  s_add_u32 s36, s32, s35
  s_addc_u32 s37, s33, 0
  global_load_lds_dwordx4 v8, s[36:37] offset:0 nt
  global_load_lds_dwordx4 v9, s[36:37] offset:1024 nt
  global_load_lds_dwordx4 v10, s[36:37] offset:2048 nt
  global_load_lds_dwordx4 v11, s[36:37] offset:3072 nt
  s_add_u32 s34, s50, 3
  s_and_b32 s34, s34, 7
  s_lshl_b32 s35, s34, 12
  s_mov_b32 m0, 45056
  s_add_u32 s36, s32, s35
  s_addc_u32 s37, s33, 0
  global_load_lds_dwordx4 v8, s[36:37] offset:0 nt
  global_load_lds_dwordx4 v9, s[36:37] offset:1024 nt
  global_load_lds_dwordx4 v10, s[36:37] offset:2048 nt
  global_load_lds_dwordx4 v11, s[36:37] offset:3072 nt
  s_add_u32 s34, s50, 4
  s_and_b32 s34, s34, 7
  s_lshl_b32 s35, s34, 12
  s_mov_b32 m0, 49152
  s_add_u32 s36, s32, s35
  s_addc_u32 s37, s33, 0
  global_load_lds_dwordx4 v8, s[36:37] offset:0 nt
  global_load_lds_dwordx4 v9, s[36:37] offset:1024 nt
  global_load_lds_dwordx4 v10, s[36:37] offset:2048 nt
  global_load_lds_dwordx4 v11, s[36:37] offset:3072 nt
  s_add_u32 s34, s50, 5
  s_and_b32 s34, s34, 7
  s_lshl_b32 s35, s34, 12
  s_mov_b32 m0, 53248
  s_add_u32 s36, s32, s35
  s_addc_u32 s37, s33, 0
  global_load_lds_dwordx4 v8, s[36:37] offset:0 nt
  global_load_lds_dwordx4 v9, s[36:37] offset:1024 nt
  global_load_lds_dwordx4 v10, s[36:37] offset:2048 nt
  global_load_lds_dwordx4 v11, s[36:37] offset:3072 nt
  s_add_u32 s34, s50, 6
  s_and_b32 s34, s34, 7
  s_lshl_b32 s35, s34, 12
  s_mov_b32 m0, 57344
  s_add_u32 s36, s32, s35
  s_addc_u32 s37, s33, 0
  global_load_lds_dwordx4 v8, s[36:37] offset:0 nt
  global_load_lds_dwordx4 v9, s[36:37] offset:1024 nt
  global_load_lds_dwordx4 v10, s[36:37] offset:2048 nt
  global_load_lds_dwordx4 v11, s[36:37] offset:3072 nt
  s_waitcnt vmcnt(24)
  v_mov_b32 v126, 5
  ds_write_b8 v127, v126 offset:20
  s_add_u32 s34, s50, 7
  s_and_b32 s34, s34, 7
  s_lshl_b32 s35, s34, 12
  s_mov_b32 m0, 61440
  s_add_u32 s36, s32, s35
  s_addc_u32 s37, s33, 0
  global_load_lds_dwordx4 v8, s[36:37] offset:0 nt
  global_load_lds_dwordx4 v9, s[36:37] offset:1024 nt
  global_load_lds_dwordx4 v10, s[36:37] offset:2048 nt
  global_load_lds_dwordx4 v11, s[36:37] offset:3072 nt
  s_waitcnt vmcnt(24)
  s_add_u32 s34, s50, 0
  s_and_b32 s34, s34, 7
  s_lshl_b32 s35, s34, 12
  s_mov_b32 m0, 65536
  s_add_u32 s36, s38, s35
  s_addc_u32 s37, s39, 0
  global_load_lds_dwordx4 v12, s[36:37] offset:0 nt
  global_load_lds_dwordx4 v13, s[36:37] offset:1024 nt
  global_load_lds_dwordx4 v12, s[36:37] offset:2048 nt
  global_load_lds_dwordx4 v13, s[36:37] offset:3072 nt
  s_waitcnt vmcnt(24)
  v_mov_b32 v126, 7
  ds_write_b8 v127, v126 offset:20
  s_add_u32 s34, s50, 1
  s_and_b32 s34, s34, 7
  s_lshl_b32 s35, s34, 12
  s_mov_b32 m0, 69632
  s_add_u32 s36, s38, s35
  s_addc_u32 s37, s39, 0
  global_load_lds_dwordx4 v12, s[36:37] offset:0 nt
  global_load_lds_dwordx4 v13, s[36:37] offset:1024 nt
  global_load_lds_dwordx4 v12, s[36:37] offset:2048 nt
  global_load_lds_dwordx4 v13, s[36:37] offset:3072 nt
  s_waitcnt vmcnt(24)
  s_add_u32 s34, s50, 2
  s_and_b32 s34, s34, 7
  s_lshl_b32 s35, s34, 12
  s_mov_b32 m0, 73728
  s_add_u32 s36, s38, s35
  s_addc_u32 s37, s39, 0
  global_load_lds_dwordx4 v12, s[36:37] offset:0 nt
  global_load_lds_dwordx4 v13, s[36:37] offset:1024 nt
  global_load_lds_dwordx4 v12, s[36:37] offset:2048 nt
  global_load_lds_dwordx4 v13, s[36:37] offset:3072 nt
  s_waitcnt vmcnt(24)
  s_add_u32 s34, s50, 3
  s_and_b32 s34, s34, 7
  s_lshl_b32 s35, s34, 12
  s_mov_b32 m0, 77824
  s_add_u32 s36, s38, s35
  s_addc_u32 s37, s39, 0
  global_load_lds_dwordx4 v12, s[36:37] offset:0 nt
  global_load_lds_dwordx4 v13, s[36:37] offset:1024 nt
  global_load_lds_dwordx4 v12, s[36:37] offset:2048 nt
  global_load_lds_dwordx4 v13, s[36:37] offset:3072 nt
  s_waitcnt vmcnt(24)
  v_mov_b32 v126, 10
  ds_write_b8 v127, v126 offset:20
  s_add_u32 s34, s50, 4
  s_and_b32 s34, s34, 7
  s_lshl_b32 s35, s34, 12
  s_mov_b32 m0, 81920
  s_add_u32 s36, s38, s35
  s_addc_u32 s37, s39, 0
  global_load_lds_dwordx4 v12, s[36:37] offset:0 nt
  global_load_lds_dwordx4 v13, s[36:37] offset:1024 nt
  global_load_lds_dwordx4 v12, s[36:37] offset:2048 nt
  global_load_lds_dwordx4 v13, s[36:37] offset:3072 nt
  s_waitcnt vmcnt(24)
  v_mov_b32 v126, 11
  ds_write_b8 v127, v126 offset:20
  s_add_u32 s34, s50, 5
  s_and_b32 s34, s34, 7
  s_lshl_b32 s35, s34, 12
  s_mov_b32 m0, 86016
  s_add_u32 s36, s38, s35
  s_addc_u32 s37, s39, 0
  global_load_lds_dwordx4 v12, s[36:37] offset:0 nt
  global_load_lds_dwordx4 v13, s[36:37] offset:1024 nt
  global_load_lds_dwordx4 v12, s[36:37] offset:2048 nt
  global_load_lds_dwordx4 v13, s[36:37] offset:3072 nt
  s_waitcnt vmcnt(24)
  v_mov_b32 v126, 12
  ds_write_b8 v127, v126 offset:20
  s_add_u32 s34, s50, 6
  s_and_b32 s34, s34, 7
  s_lshl_b32 s35, s34, 12
  s_mov_b32 m0, 90112
  s_add_u32 s36, s38, s35
  s_addc_u32 s37, s39, 0
  global_load_lds_dwordx4 v12, s[36:37] offset:0 nt
  global_load_lds_dwordx4 v13, s[36:37] offset:1024 nt
  global_load_lds_dwordx4 v12, s[36:37] offset:2048 nt
  global_load_lds_dwordx4 v13, s[36:37] offset:3072 nt
  s_waitcnt vmcnt(24)
  v_mov_b32 v126, 13
  ds_write_b8 v127, v126 offset:20
  s_add_u32 s34, s50, 7
  s_and_b32 s34, s34, 7
  s_lshl_b32 s35, s34, 12
  s_mov_b32 m0, 94208
  s_add_u32 s36, s38, s35
  s_addc_u32 s37, s39, 0
  global_load_lds_dwordx4 v12, s[36:37] offset:0 nt
  global_load_lds_dwordx4 v13, s[36:37] offset:1024 nt
  global_load_lds_dwordx4 v12, s[36:37] offset:2048 nt
  global_load_lds_dwordx4 v13, s[36:37] offset:3072 nt
  s_waitcnt vmcnt(24)
  v_mov_b32 v126, 14
  ds_write_b8 v127, v126 offset:20
  s_add_u32 s34, s51, 0
  s_and_b32 s34, s34, 3
  s_mul_i32 s35, s34, 16384
  s_lshl_b32 s34, s34, 12
  s_add_u32 m0, s34, 98304
  s_add_u32 s36, s40, s35
  s_addc_u32 s37, s41, 0
  global_load_lds_dwordx4 v14, s[36:37] offset:0 nt
  global_load_lds_dwordx4 v15, s[36:37] offset:1024 nt
  global_load_lds_dwordx4 v16, s[36:37] offset:2048 nt
  global_load_lds_dwordx4 v17, s[36:37] offset:3072 nt
  s_waitcnt vmcnt(24)
  s_add_u32 s34, s51, 1
  s_and_b32 s34, s34, 3
  s_mul_i32 s35, s34, 16384
  s_lshl_b32 s34, s34, 12
  s_add_u32 m0, s34, 98304
  s_add_u32 s36, s40, s35
  s_addc_u32 s37, s41, 0
  global_load_lds_dwordx4 v14, s[36:37] offset:0 nt
  global_load_lds_dwordx4 v15, s[36:37] offset:1024 nt
  global_load_lds_dwordx4 v16, s[36:37] offset:2048 nt
  global_load_lds_dwordx4 v17, s[36:37] offset:3072 nt
  s_waitcnt vmcnt(24)
  v_mov_b32 v126, 16
  ds_write_b8 v127, v126 offset:20
  s_add_u32 s34, s51, 2
  s_and_b32 s34, s34, 3
  s_mul_i32 s35, s34, 16384
  s_lshl_b32 s34, s34, 12
  s_add_u32 m0, s34, 98304
  s_add_u32 s36, s40, s35
  s_addc_u32 s37, s41, 0
  global_load_lds_dwordx4 v14, s[36:37] offset:0 nt
  global_load_lds_dwordx4 v15, s[36:37] offset:1024 nt
  global_load_lds_dwordx4 v16, s[36:37] offset:2048 nt
  global_load_lds_dwordx4 v17, s[36:37] offset:3072 nt
  s_waitcnt vmcnt(24)
  s_add_u32 s34, s51, 3
  s_and_b32 s34, s34, 3
  s_mul_i32 s35, s34, 16384
  s_lshl_b32 s34, s34, 12
  s_add_u32 m0, s34, 98304
  s_add_u32 s36, s40, s35
  s_addc_u32 s37, s41, 0
  global_load_lds_dwordx4 v14, s[36:37] offset:0 nt
  global_load_lds_dwordx4 v15, s[36:37] offset:1024 nt
  global_load_lds_dwordx4 v16, s[36:37] offset:2048 nt
  global_load_lds_dwordx4 v17, s[36:37] offset:3072 nt
  v_mov_b32 v126, 18
  s_waitcnt vmcnt(24)
  ds_write_b8 v127, v126 offset:20
  v_mov_b32 v126, 20
  s_waitcnt vmcnt(16)
  ds_write_b8 v127, v126 offset:20
  v_mov_b32 v126, 24
  s_waitcnt vmcnt(0)
  ds_write_b8 v127, v126 offset:20
  v_mov_b32 v126, 26
  s_waitcnt vmcnt(0)
  ds_write_b8 v127, v126 offset:20
  s_endpgm
L_f2:
  s_lshr_b32 s31, s2, 6
  s_bfe_u32 s34, s2, 0x30003
  s_mul_i32 s30, s31, 7
  s_add_u32 s30, s30, s34
  s_cmp_gt_u32 s34, 3
  s_subb_u32 s30, s30, 0
  s_add_u32 s31, s31, 28
  s_cmp_eq_u32 s34, 3
  s_cselect_b32 s30, s31, s30
  s_and_b32 s52, s30, 24
  s_and_b32 s93, s30, 7
  s_and_b32 s31, s29, 3
  s_and_b32 s34, s29, 4
  s_cmp_ge_u32 s30, 24
  s_cselect_b32 s31, s31, s29
  s_cselect_b32 s34, s34, 0
  s_cselect_b32 s91, 1048576, 0
  s_add_u32 s52, s52, s31
  s_add_u32 s93, s93, s34
  v_mov_b32 v127, 130048
  v_mov_b32 v126, 1
  s_mov_b32 s59, 0x800000
  v_lshrrev_b32 v4, 3, v1
  v_mov_b32 v13, 0
  s_mov_b32 s54, 0x00010001
  s_mov_b32 s55, s54
  s_sub_u32 s53, s28, 4
  s_lshl_b32 s46, s52, 11
  s_add_u32 s46, s46, 131072
  s_add_u32 s46, s46, s91
  s_lshl_b32 s34, s93, 8
  s_add_u32 s31, s46, s34
  s_lshl_b32 s34, s53, 7
  s_add_u32 s31, s31, s34
  v_lshl_add_u32 v108, v5, 4, s31
  v_mov_b32 v109, v108
  v_mov_b32 v110, v108
  s_lshl_b32 s47, s29, 2
  s_and_b32 s34, s30, 3
  s_add_u32 s47, s47, s34
  s_lshl_b32 s34, s53, 5
  s_add_u32 s47, s47, s34
  s_cmp_ge_u32 s30, 28
  s_cselect_b32 s47, s47, 16
  s_cmp_ge_u32 s47, 16
  s_cbranch_scc1 L_noz
  s_lshl_b32 s34, s47, 10
  s_add_u32 s34, s34, 106496
  v_lshl_add_u32 v16, v6, 3, s34
  v_lshl_add_u32 v16, v5, 8, v16
  v_mov_b32 v18, 0
  v_mov_b32 v19, 0
  global_store_dwordx2 v16, v[18:19], s[26:27] sc1
  s_waitcnt vmcnt(1)
  s_branch L_ln
  L_noz:
  s_waitcnt vmcnt(0)
  s_branch L_ln
L_w2:
  s_lshr_b32 s31, s2, 6
  s_bfe_u32 s34, s2, 0x30003
  s_mul_i32 s30, s31, 7
  s_add_u32 s30, s30, s34
  s_cmp_gt_u32 s34, 3
  s_subb_u32 s30, s30, 0
  s_add_u32 s31, s31, 28
  s_cmp_eq_u32 s34, 3
  s_cselect_b32 s30, s31, s30
  v_mov_b32 v127, 130048
  v_mov_b32 v126, 1
  s_mov_b32 s59, 0x800000
  v_lshrrev_b32 v5, 4, v1
  v_and_b32 v6, 15, v1
  v_mov_b32 v13, 0
  s_lshr_b32 s52, s2, 3
  s_mov_b32 s54, 0x00010001
  s_mov_b32 s55, s54
  s_mov_b32 s56, 0x000f000f
  s_mov_b32 s57, s56
  s_lshl_b32 s31, s29, 13
  s_add_u32 s46, s31, 4096
  s_lshr_b32 s31, s52, 3
  s_lshl_b32 s31, s31, 11
  s_add_u32 s31, s31, s46
  s_and_b32 s34, s52, 7
  s_lshl_b32 s34, s34, 8
  s_add_u32 s31, s31, s34
  s_lshl_b32 s34, s28, 6
  s_add_u32 s31, s31, s34
  v_lshl_add_u32 v108, v5, 4, s31
  s_lshl_b32 s35, s29, 5
  s_add_u32 s35, s35, s30
  s_lshl_b32 s31, s35, 11
  s_lshl_b32 s34, s28, 7
  s_add_u32 s31, s31, s34
  s_add_u32 s31, s31, 262144
  v_and_b32 v109, 3, v6
  v_lshlrev_b32 v109, 9, v109
  v_lshl_add_u32 v109, v5, 4, v109
  v_add_u32 v109, s31, v109
  s_lshl_b32 s31, s29, 13
  s_lshl_b32 s34, s28, 11
  s_add_u32 s31, s31, s34
  s_lshl_b32 s34, s30, 4
  s_add_u32 s31, s31, s34
  s_add_u32 s31, s31, 786432
  v_and_b32 v110, 3, v6
  v_lshl_add_u32 v110, v110, 9, s31
  s_mov_b64 s[50:51], 15
  s_waitcnt vmcnt(4)
L_ln:
  s_waitcnt lgkmcnt(0)
  s_add_u32 s3, s3, 1
  v_mov_b32 v122, s3
  v_lshrrev_b32 v112, 8, v122
  s_mov_b32 s40, 0xffff0000
  s_movk_i32 s44, 0xff
  s_mov_b32 s45, 0xffffff00
  v_mov_b32 v30, 0x3b000000
  v_lshlrev_b32 v16, 16, v8
  v_and_b32 v17, s40, v8
  v_lshlrev_b32 v18, 16, v9
  v_and_b32 v19, s40, v9
  v_lshlrev_b32 v20, 16, v10
  v_and_b32 v21, s40, v10
  v_lshlrev_b32 v22, 16, v11
  v_and_b32 v23, s40, v11
  v_add_f32 v24, v16, v17
  v_add_f32 v25, v18, v19
  v_add_f32 v26, v20, v21
  v_add_f32 v27, v22, v23
  v_add_f32 v24, v24, v25
  v_add_f32 v26, v26, v27
  v_add_f32 v24, v24, v26
  s_nop 1
  v_add_f32_dpp v24, v24, v24 row_ror:8 row_mask:0xf bank_mask:0xf
  s_nop 1
  v_add_f32_dpp v24, v24, v24 row_ror:4 row_mask:0xf bank_mask:0xf
  s_nop 1
  v_add_f32_dpp v24, v24, v24 row_ror:2 row_mask:0xf bank_mask:0xf
  s_nop 1
  v_add_f32_dpp v24, v24, v24 row_ror:1 row_mask:0xf bank_mask:0xf
  s_nop 1
  v_add_f32_dpp v24, v24, v24 row_bcast:15 row_mask:0xa bank_mask:0xf
  s_nop 1
  v_add_f32_dpp v24, v24, v24 row_bcast:31 row_mask:0xc bank_mask:0xf
  s_nop 0
  v_readlane_b32 s41, v24, 63
  s_nop 1
  v_mul_f32 v25, s41, v30
  v_sub_f32 v32, v16, v25
  v_sub_f32 v33, v17, v25
  v_sub_f32 v34, v18, v25
  v_sub_f32 v35, v19, v25
  v_sub_f32 v36, v20, v25
  v_sub_f32 v37, v21, v25
  v_sub_f32 v38, v22, v25
  v_sub_f32 v39, v23, v25
  v_mul_f32 v26, v32, v32
  v_mul_f32 v27, v33, v33
  v_fmac_f32 v26, v34, v34
  v_fmac_f32 v27, v35, v35
  v_fmac_f32 v26, v36, v36
  v_fmac_f32 v27, v37, v37
  v_fmac_f32 v26, v38, v38
  v_fmac_f32 v27, v39, v39
  v_add_f32 v26, v26, v27
  s_nop 1
  v_add_f32_dpp v26, v26, v26 row_ror:8 row_mask:0xf bank_mask:0xf
  s_nop 1
  v_add_f32_dpp v26, v26, v26 row_ror:4 row_mask:0xf bank_mask:0xf
  s_nop 1
  v_add_f32_dpp v26, v26, v26 row_ror:2 row_mask:0xf bank_mask:0xf
  s_nop 1
  v_add_f32_dpp v26, v26, v26 row_ror:1 row_mask:0xf bank_mask:0xf
  s_nop 1
  v_add_f32_dpp v26, v26, v26 row_bcast:15 row_mask:0xa bank_mask:0xf
  s_nop 1
  v_add_f32_dpp v26, v26, v26 row_bcast:31 row_mask:0xc bank_mask:0xf
  s_nop 0
  v_readlane_b32 s42, v26, 63
  s_nop 1
  v_mul_f32 v26, s42, v30
  v_cvt_pk_bf16_f32 v27, v26, v25
  v_lshlrev_b32 v26, 16, v27
  v_and_b32 v25, s40, v27
  v_add_f32 v26, 0x3727c5ac, v26
  v_cvt_pk_bf16_f32 v26, v26, v26
  v_and_b32 v26, s40, v26
  v_sqrt_f32 v26, v26
  v_sub_f32 v32, v16, v25
  v_sub_f32 v33, v17, v25
  v_sub_f32 v34, v18, v25
  v_sub_f32 v35, v19, v25
  v_sub_f32 v36, v20, v25
  v_sub_f32 v37, v21, v25
  v_sub_f32 v38, v22, v25
  v_sub_f32 v39, v23, v25
  v_cvt_pk_bf16_f32 v26, v26, v26
  v_and_b32 v26, s40, v26
  v_rcp_f32 v26, v26
  v_cvt_pk_bf16_f32 v40, v32, v33
  v_cvt_pk_bf16_f32 v41, v34, v35
  v_cvt_pk_bf16_f32 v42, v36, v37
  v_cvt_pk_bf16_f32 v43, v38, v39
  v_lshlrev_b32 v32, 16, v40
  v_and_b32 v33, s40, v40
  v_lshlrev_b32 v34, 16, v41
  v_and_b32 v35, s40, v41
  v_lshlrev_b32 v36, 16, v42
  v_and_b32 v37, s40, v42
  v_lshlrev_b32 v38, 16, v43
  v_and_b32 v39, s40, v43
  v_mul_f32 v32, v32, v26
  v_mul_f32 v33, v33, v26
  v_mul_f32 v34, v34, v26
  v_mul_f32 v35, v35, v26
  v_mul_f32 v36, v36, v26
  v_mul_f32 v37, v37, v26
  v_mul_f32 v38, v38, v26
  v_mul_f32 v39, v39, v26
  v_cvt_pk_bf16_f32 v40, v32, v33
  v_cvt_pk_bf16_f32 v41, v34, v35
  v_cvt_pk_bf16_f32 v42, v36, v37
  v_cvt_pk_bf16_f32 v43, v38, v39
  v_add_u32 v12, 122880, v3
  ds_write_b128 v12, v[40:43]
  v_lshrrev_b32 v14, 2, v6
  v_and_b32 v15, 3, v6
  v_lshl_add_u32 v14, v5, 2, v14
  s_cmp_ge_u32 s28, 4
  s_cbranch_scc1 L_fmain
  v_add_u32 v123, s28, v127
  s_lshr_b32 s31, s52, 3
  s_lshl_b32 s31, s31, 8
  s_add_u32 s31, s31, 122880
  v_lshl_add_u32 v12, v5, 3, s31
  ds_read2_b64 v[32:35], v12 offset0:0 offset1:4
  ds_read2_b64 v[36:39], v12 offset0:8 offset1:12
  ds_read2_b64 v[40:43], v12 offset0:16 offset1:20
  ds_read2_b64 v[44:47], v12 offset0:24 offset1:28
  v_lshrrev_b32 v16, 1, v14
  v_and_b32 v16, 3, v16
  v_xor_b32 v16, s28, v16
  v_lshlrev_b32 v16, 5, v16
  v_and_b32 v17, 7, v14
  v_lshl_add_u32 v16, v17, 7, v16
  v_lshrrev_b32 v17, 1, v5
  v_lshl_add_u32 v16, v17, 12, v16
  v_lshl_add_u32 v16, v15, 3, v16
  v_and_b32 v17, 1, v5
  v_lshlrev_b32 v17, 1, v17
  v_lshrrev_b32 v18, 1, v5
  v_or_b32 v17, v17, v18
  v_mov_b32 v114, v17
  s_getreg_b32 s58, hwreg(HW_REG_XCC_ID, 0, 4)
  s_lshl_b32 s58, s58, 8
  s_lshl_b32 s49, s29, 9
  s_add_u32 s49, s49, 98304
  s_cmp_lg_u32 s28, 0
  s_cbranch_scc1 L_noxc
  v_mov_b32 v20, s58
  s_lshl_b32 s31, s30, 4
  s_add_u32 s31, s31, s49
  v_bfi_b32 v20, s44, v122, v20
  v_mov_b32 v19, s31
  v_mov_b32 v21, v20
  v_mov_b32 v22, v112
  v_mov_b32 v23, v112
  s_mov_b64 exec, 1
  global_store_dwordx4 v19, v[20:23], s[26:27]
  s_mov_b64 exec, -1
  s_waitcnt vmcnt(1)
  s_branch L_xcd
L_noxc:
  s_waitcnt vmcnt(0)
L_xcd:
  ds_write_b8 v123, v126 offset:0
LP_1:
  ds_read_b32 v2, v127 offset:0
  ds_read_b64_tr_b16 v[48:49], v16 offset:0
  ds_read_b64_tr_b16 v[50:51], v16 offset:8192
  ds_read_b64_tr_b16 v[52:53], v16 offset:1024
  ds_read_b64_tr_b16 v[54:55], v16 offset:9216
  ds_read_b64_tr_b16 v[56:57], v16 offset:2048
  ds_read_b64_tr_b16 v[58:59], v16 offset:10240
  ds_read_b64_tr_b16 v[60:61], v16 offset:3072
  ds_read_b64_tr_b16 v[62:63], v16 offset:11264
  s_sub_u32 s59, s59, 1
  s_cmp_lt_i32 s59, 0
  s_cbranch_scc1 LD_2
  s_waitcnt lgkmcnt(0)
  v_cmp_ne_u32 vcc, 0x01010101, v2
  s_cbranch_vccnz LP_1
LD_2:
  s_waitcnt lgkmcnt(0)
  v_mfma_f32_16x16x32_bf16 v[196:199], v[48:51], v[32:35], 0
  v_mfma_f32_16x16x32_bf16 v[196:199], v[52:55], v[36:39], v[196:199]
  v_mfma_f32_16x16x32_bf16 v[196:199], v[56:59], v[40:43], v[196:199]
  v_mfma_f32_16x16x32_bf16 v[196:199], v[60:63], v[44:47], v[196:199]
  s_lshl_b32 s31, s28, 13
  s_add_u32 s31, s31, 32768
  v_xor_b32 v24, v5, v6
  v_lshlrev_b32 v24, 4, v24
  v_lshl_add_u32 v24, v6, 8, v24
  v_add_u32 v24, s31, v24
  v_xor_b32 v25, 64, v24
  v_xor_b32 v26, 0x80, v24
  v_xor_b32 v27, 0xc0, v24
  v_add_u32 v196, 0x80, v196
  v_add_u32 v197, 0x80, v197
  v_add_u32 v198, 0x80, v198
  v_add_u32 v199, 0x80, v199
  v_bfi_b32 v196, s44, v122, v196
  v_bfi_b32 v197, s44, v122, v197
  v_bfi_b32 v198, s44, v112, v198
  v_bfi_b32 v199, s44, v112, v199
  s_mov_b64 exec, s[54:55]
  global_store_dwordx4 v108, v[196:199], s[26:27]
  s_mov_b64 exec, -1
  v_lshrrev_b32 v19, 5, v1
  v_and_b32 v29, 31, v1
  v_lshl_add_u32 v30, v29, 4, s49
  v_lshlrev_b32 v28, 11, v19
  v_lshl_add_u32 v28, v29, 4, v28
  s_lshl_b32 s31, s28, 9
  s_add_u32 s31, s31, s46
  s_add_u32 s31, s31, 2048
  v_add_u32 v28, s31, v28
  v_lshl_add_u32 v29, v29, 2, v19
  s_mul_i32 s31, s28, 272
  s_add_u32 s31, s31, 123904
  v_lshl_add_u32 v29, v29, 1, s31
  v_mul_u32_u24 v31, 272, v15
  v_lshl_add_u32 v31, v5, 4, v31
  v_add_u32 v31, 123904, v31
  v_lshlrev_b32 v8, 2, v15
  v_add_u32 v8, 129280, v8
  v_lshl_add_u32 v10, v5, 2, v15
  v_lshlrev_b32 v10, 4, v10
  v_add_u32 v10, 125184, v10
  v_and_b32 v9, 12, v6
  s_lshl_b32 s31, s28, 8
  v_add3_u32 v9, v9, v10, s31
  s_lshl_b32 s31, s28, 1
  v_and_b32 v20, 7, v14
  v_xor_b32 v20, s31, v20
  v_lshlrev_b32 v20, 5, v20
  v_lshl_add_u32 v20, v14, 8, v20
  v_lshl_add_u32 v20, v15, 3, v20
  v_add_u32 v22, 98304, v20
  v_add_u32 v20, 65536, v20
  v_xor_b32 v21, 32, v20
  v_xor_b32 v23, 32, v22
  s_lshr_b32 s34, s30, 3
  s_lshl_b32 s31, s29, 16
  s_lshl_b32 s35, s34, 9
  s_add_u32 s31, s31, s35
  s_bfe_u32 s35, s30, 0x10002
  s_lshl_b32 s35, s35, 8
  s_add_u32 s31, s31, s35
  s_lshl_b32 s35, s28, 6
  s_add_u32 s31, s31, s35
  s_add_u32 s31, s31, 262144
  v_lshrrev_b32 v19, 2, v1
  v_lshlrev_b32 v17, 11, v19
  v_lshl_add_u32 v17, v15, 4, v17
  v_add_u32 v17, s31, v17
  v_add_u32 v18, 0x8000, v17
  s_lshl_b32 s31, s29, 13
  s_lshl_b32 s34, s34, 9
  s_add_u32 s31, s31, s34
  s_bfe_u32 s35, s30, 0x10002
  s_lshl_b32 s35, s35, 12
  s_add_u32 s31, s31, s35
  s_lshr_b32 s35, s28, 1
  s_lshl_b32 s35, s35, 11
  s_add_u32 s31, s31, s35
  s_add_u32 s31, s31, 786432
  v_lshl_add_u32 v19, v19, 4, s31
  s_lshl_b32 s31, s28, 4
  v_lshl_add_u32 v96, v15, 2, v114
  v_add_u32 v96, s31, v96
  v_lshlrev_b32 v96, 1, v96
  v_add_u32 v96, 129792, v96
  v_lshlrev_b32 v97, 3, v5
  v_add_u32 v97, 129792, v97
  s_and_b32 s31, s30, 3
  s_lshl_b32 s31, s31, 2
  s_add_u32 s43, s31, s28
  s_lshl_b32 s31, s43, 10
  s_add_u32 s31, s31, 106496
  v_lshrrev_b32 v113, 3, v6
  v_lshlrev_b32 v113, 4, v113
  v_lshl_add_u32 v113, v5, 2, v113
  v_bfe_u32 v98, v6, 1, 2
  v_add_u32 v113, v113, v98
  v_and_b32 v99, 1, v6
  v_lshrrev_b32 v98, 3, v113
  v_lshlrev_b32 v98, 7, v98
  v_lshl_add_u32 v98, v113, 4, v98
  v_lshl_add_u32 v98, v99, 3, v98
  v_add_u32 v98, s31, v98
  v_cmp_eq_u32 vcc, 0, v99
  s_lshl_b32 s31, s43, 15
  s_add_u32 s31, s31, 2097152
  v_lshl_add_u32 v99, v1, 3, s31
  s_lshl_b32 s34, s29, 3
  s_lshr_b32 s35, s30, 2
  s_add_u32 s34, s34, s35
  s_lshl_b32 s34, s34, 9
  v_add_u32 v111, s34, v99
  s_lshl_b32 s31, s28, 7
  s_add_u32 s31, s31, 130304
  v_lshl_add_u32 v121, v113, 2, s31
  s_lshl_b32 s31, s43, 6
  v_lshl_add_u32 v115, v113, 1, s31
  global_load_ushort v113, v115, s[4:5]
  v_mov_b32 v100, 0x4d000000
  v_mov_b32 v101, 0x52000000
  v_cndmask_b32 v100, v100, v101, vcc
  v_mov_b32 v101, 0x32000000
  v_mov_b32 v102, 0x2d000000
  v_cndmask_b32 v101, v101, v102, vcc
  v_mov_b32 v102, 0x02000000
  v_mov_b32 v103, 0x81
  s_mov_b32 s96, 0
  s_mov_b32 s97, 0x43380000
  s_mov_b32 s98, 0x51800000
  s_mov_b32 s99, 0x4a800000
  s_mov_b32 s100, 0xcccccccc
  s_mov_b32 s101, s100
  v_mov_b32 v104, 0x3f803f80
  v_mov_b32 v105, 0x3f803f80
  v_mov_b32 v106, 0x3f803f80
  v_mov_b32 v107, 0x3f803f80
  v_mov_b32 v62, 0
  v_mov_b32 v63, 0
  s_mov_b32 s36, 0xf0f0f0f0
  s_mov_b32 s37, s36
  s_mov_b32 s38, 0xff00ff00
  s_mov_b32 s39, s38
  s_mov_b32 s47, 0x3db504f3
  s_mov_b32 s48, 0x3fb8aa3b
  v_bfi_b32 v62, s44, v112, v62
  v_bfi_b32 v63, s44, v112, v63
LP_3:
  ds_read_b32 v2, v127 offset:20
  s_sub_u32 s59, s59, 1
  s_cmp_lt_i32 s59, 0
  s_cbranch_scc1 LD_4
  s_waitcnt lgkmcnt(0)
  v_cmp_gt_u32 vcc, 7, v2
  s_cbranch_vccnz LP_3
LD_4:
  s_waitcnt lgkmcnt(0)
  global_load_dwordx4 v[128:131], v28, s[26:27] offset:-2048 sc1
  global_load_dwordx4 v[132:135], v28, s[26:27] offset:2048 sc1
  global_load_dwordx4 v[136:139], v30, s[26:27] sc1
LP_5:
  ds_read_b32 v2, v127 offset:20
  s_sub_u32 s59, s59, 1
  s_cmp_lt_i32 s59, 0
  s_cbranch_scc1 LD_6
  s_waitcnt lgkmcnt(0)
  v_cmp_gt_u32 vcc, 11, v2
  s_cbranch_vccnz LP_5
LD_6:
  s_waitcnt lgkmcnt(0)
  global_load_dwordx4 v[140:143], v28, s[26:27] offset:-2048 sc1
  global_load_dwordx4 v[144:147], v28, s[26:27] offset:2048 sc1
  global_load_dwordx4 v[148:151], v30, s[26:27] sc1
  s_waitcnt vmcnt(3)
  ds_read_b32 v2, v127 offset:20
  ds_read_b128 v[64:67], v24 offset:0
  ds_read_b128 v[80:83], v24 offset:4096
  ds_read_b128 v[68:71], v25 offset:0
  ds_read_b128 v[84:87], v25 offset:4096
  ds_read_b128 v[72:75], v26 offset:0
  ds_read_b128 v[88:91], v26 offset:4096
  ds_read_b128 v[76:79], v27 offset:0
  ds_read_b128 v[92:95], v27 offset:4096
  v_bitop3_b32 v116, v128, v129, v122 bitop3:0x7e
  v_bitop3_b32 v117, v130, v131, v112 bitop3:0x7e
  v_bitop3_b32 v118, v132, v133, v122 bitop3:0x7e
  v_or3_b32 v116, v116, v117, v118
  v_bitop3_b32 v117, v134, v135, v112 bitop3:0x7e
  v_bitop3_b32 v118, v136, v137, v122 bitop3:0x7e
  v_or3_b32 v116, v116, v117, v118
  v_bitop3_b32 v117, v138, v139, v112 bitop3:0x7e
  v_bitop3_b32 v116, v116, v117, s44 bitop3:0xa8
  v_cmp_ne_u32 vcc, 0, v116
  s_cbranch_vccnz L_qf0
  v_and_b32 v32, s45, v128
  v_and_b32 v33, s45, v129
  v_and_b32 v34, s45, v130
  v_and_b32 v35, s45, v131
  v_and_b32 v36, s45, v132
  v_and_b32 v37, s45, v133
  v_and_b32 v38, s45, v134
  v_and_b32 v39, s45, v135
  v_and_b32 v40, s45, v136
  s_branch L_qok
L_qf0:
  s_waitcnt vmcnt(0)
  v_bitop3_b32 v116, v140, v141, v122 bitop3:0x7e
  v_bitop3_b32 v117, v142, v143, v112 bitop3:0x7e
  v_bitop3_b32 v118, v144, v145, v122 bitop3:0x7e
  v_or3_b32 v116, v116, v117, v118
  v_bitop3_b32 v117, v146, v147, v112 bitop3:0x7e
  v_bitop3_b32 v118, v148, v149, v122 bitop3:0x7e
  v_or3_b32 v116, v116, v117, v118
  v_bitop3_b32 v117, v150, v151, v112 bitop3:0x7e
  v_bitop3_b32 v116, v116, v117, s44 bitop3:0xa8
  v_cmp_ne_u32 vcc, 0, v116
  s_cbranch_vccnz L_qf1
  v_and_b32 v32, s45, v140
  v_and_b32 v33, s45, v141
  v_and_b32 v34, s45, v142
  v_and_b32 v35, s45, v143
  v_and_b32 v36, s45, v144
  v_and_b32 v37, s45, v145
  v_and_b32 v38, s45, v146
  v_and_b32 v39, s45, v147
  v_and_b32 v40, s45, v148
  s_branch L_qok
L_qf1:
  s_mov_b32 s62, 0
GP_7:
  global_load_dwordx4 v[32:35], v28, s[26:27] offset:-2048 sc1
  global_load_dwordx4 v[36:39], v28, s[26:27] offset:2048 sc1
  global_load_dwordx4 v[40:43], v30, s[26:27] offset:0 sc1
  s_add_u32 s62, s62, 1
  s_and_b32 s63, s62, 7
  s_cmp_lt_u32 s63, 7
  s_cselect_b32 s63, 0, 1048576
  s_sub_u32 s59, s59, 16
  s_cmp_lt_i32 s59, 0
  s_cbranch_scc1 GD_8
  v_and_b32 v28, 1048575, v28
  v_or_b32 v28, s63, v28
  v_and_b32 v30, 1048575, v30
  v_or_b32 v30, s63, v30
  s_waitcnt vmcnt(0)
  s_cmp_eq_u32 s63, 0
  s_cbranch_scc1 GN_9
  s_mov_b64 s[94:95], exec
  s_mov_b64 exec, s[54:55]
  v_add_u32 v116, 1048576, v108
  global_store_dwordx4 v116, v[196:199], s[26:27] sc1
  s_cmp_lg_u32 s28, 0
  s_cbranch_scc1 QG_10
  s_mov_b64 exec, 1
  s_getreg_b32 s31, hwreg(HW_REG_XCC_ID, 0, 4)
  s_lshl_b32 s31, s31, 8
  v_mov_b32 v116, s31
  s_lshl_b32 s31, s30, 4
  s_add_u32 s31, s31, s49
  s_add_u32 s31, s31, 1048576
  v_bfi_b32 v116, s44, v122, v116
  v_mov_b32 v120, s31
  v_mov_b32 v117, v116
  v_mov_b32 v118, v112
  v_mov_b32 v119, v112
  global_store_dwordx4 v120, v[116:119], s[26:27] sc1
QG_10:
  s_waitcnt vmcnt(0)
  s_mov_b64 exec, s[94:95]
GN_9:
  v_bitop3_b32 v116, v32, v33, v122 bitop3:0x7e
  v_bitop3_b32 v117, v34, v35, v112 bitop3:0x7e
  v_or_b32 v118, v116, v117
  v_bitop3_b32 v116, v36, v37, v122 bitop3:0x7e
  v_bitop3_b32 v117, v38, v39, v112 bitop3:0x7e
  v_or3_b32 v118, v116, v117, v118
  v_bitop3_b32 v116, v40, v41, v122 bitop3:0x7e
  v_bitop3_b32 v117, v42, v43, v112 bitop3:0x7e
  v_or3_b32 v118, v116, v117, v118
  v_and_b32 v118, s44, v118
  v_cmp_ne_u32 vcc, 0, v118
  s_mov_b64 exec, vcc
  s_cbranch_execnz GP_7
GD_8:
  s_mov_b64 exec, -1
  s_waitcnt vmcnt(0)
  ds_read_b32 v2, v127 offset:20
  ds_read_b128 v[64:67], v24 offset:0
  ds_read_b128 v[80:83], v24 offset:4096
  ds_read_b128 v[68:71], v25 offset:0
  ds_read_b128 v[84:87], v25 offset:4096
  ds_read_b128 v[72:75], v26 offset:0
  ds_read_b128 v[88:91], v26 offset:4096
  ds_read_b128 v[76:79], v27 offset:0
  ds_read_b128 v[92:95], v27 offset:4096
  v_and_b32 v32, s45, v32
  v_and_b32 v33, s45, v33
  v_and_b32 v34, s45, v34
  v_and_b32 v35, s45, v35
  v_and_b32 v36, s45, v36
  v_and_b32 v37, s45, v37
  v_and_b32 v38, s45, v38
  v_and_b32 v39, s45, v39
  v_and_b32 v40, s45, v40
L_qok:
  v_add_f32 v32, v32, v36
  v_add_f32 v33, v33, v37
  v_add_f32 v34, v34, v38
  v_add_f32 v35, v35, v39
  v_cmp_ne_u32 vcc, s58, v40
  s_nop 0
  v_permlane32_swap_b32 v32, v33
  v_permlane32_swap_b32 v34, v35
  v_add_f32 v32, v32, v33
  v_add_f32 v34, v34, v35
  v_cvt_pk_bf16_f32 v32, v32, v34
  ds_write_b16 v29, v32
  ds_write_b16_d16_hi v29, v32 offset:4
  ds_write_b8 v123, v126 offset:4
  s_cmp_eq_u64 vcc, 0
  s_cselect_b32 s58, 1, 0
  s_cbranch_scc0 L_qnl
L_qnld:
  v_sub_u32 v11, 2, s58
  ds_write_b8 v127, v11 offset:36
LP_11:
  ds_read_b32 v124, v127 offset:4
  ds_read_b128 v[40:43], v31 offset:0
  ds_read_b128 v[44:47], v31 offset:64
  ds_read_b128 v[48:51], v31 offset:128
  ds_read_b128 v[52:55], v31 offset:192
  s_sub_u32 s59, s59, 1
  s_cmp_lt_i32 s59, 0
  s_cbranch_scc1 LD_12
  s_waitcnt lgkmcnt(0)
  v_cmp_ne_u32 vcc, 0x01010101, v124
  s_cbranch_vccnz LP_11
LD_12:
  s_waitcnt lgkmcnt(0)
  v_cmp_gt_u32 vcc, 12, v2
  s_cbranch_vccnz L_kslow
L_kok:
  v_mfma_f32_16x16x32_bf16 v[32:35], v[64:67], v[40:43], 0
  v_mfma_f32_16x16x32_bf16 v[36:39], v[80:83], v[40:43], 0
  v_mfma_f32_16x16x32_bf16 v[32:35], v[68:71], v[44:47], v[32:35]
  v_mfma_f32_16x16x32_bf16 v[36:39], v[84:87], v[44:47], v[36:39]
  v_mfma_f32_16x16x32_bf16 v[32:35], v[72:75], v[48:51], v[32:35]
  v_mfma_f32_16x16x32_bf16 v[36:39], v[88:91], v[48:51], v[36:39]
  v_mfma_f32_16x16x32_bf16 v[32:35], v[76:79], v[52:55], v[32:35]
  v_mfma_f32_16x16x32_bf16 v[36:39], v[92:95], v[52:55], v[36:39]
  s_nop 6
  v_cvt_pk_bf16_f32 v40, v32, v33
  v_cvt_pk_bf16_f32 v41, v34, v35
  v_cvt_pk_bf16_f32 v42, v36, v37
  v_cvt_pk_bf16_f32 v43, v38, v39
  v_cndmask_b32 v40, v40, v41, s[36:37]
  v_cndmask_b32 v42, v42, v43, s[36:37]
  v_cndmask_b32 v40, v40, v42, s[38:39]
  v_lshlrev_b32 v32, 16, v40
  v_and_b32 v33, s40, v40
  v_mul_f32 v32, s47, v32
  v_mul_f32 v33, s47, v33
  v_cvt_pk_bf16_f32 v40, v32, v33
  v_lshlrev_b32 v32, 16, v40
  v_and_b32 v33, s40, v40
  v_max_f32 v34, v32, v33
  ds_max_f32 v8, v34
  ds_write_b8 v123, v126 offset:8
LP_13:
  ds_read_b32 v2, v127 offset:8
  ds_read_b32 v60, v8
  s_sub_u32 s59, s59, 1
  s_cmp_lt_i32 s59, 0
  s_cbranch_scc1 LD_14
  s_waitcnt lgkmcnt(0)
  v_cmp_ne_u32 vcc, 0x01010101, v2
  s_cbranch_vccnz LP_13
LD_14:
  s_waitcnt lgkmcnt(0)
  v_mul_f32 v34, s48, v60
  v_fma_f32 v32, v32, s48, -v34
  v_fma_f32 v33, v33, s48, -v34
  v_exp_f32 v32, v32
  v_exp_f32 v33, v33
  s_nop 0
  v_cvt_pk_bf16_f32 v32, v32, v33
  ds_write_b32 v9, v32
  ds_write_b8 v123, v126 offset:12
  v_bfi_b32 v60, s44, v122, v60
LP_15:
  ds_read_b32 v2, v127 offset:12
  ds_read_b128 v[44:47], v10 offset:0
  ds_read_b128 v[48:51], v10 offset:256
  ds_read_b128 v[52:55], v10 offset:512
  ds_read_b128 v[56:59], v10 offset:768
  s_sub_u32 s59, s59, 1
  s_cmp_lt_i32 s59, 0
  s_cbranch_scc1 LD_16
  s_waitcnt lgkmcnt(0)
  v_cmp_ne_u32 vcc, 0x01010101, v2
  s_cbranch_vccnz LP_15
LD_16:
  s_waitcnt lgkmcnt(0)
  ds_read_b32 v125, v127 offset:20
  ds_read_b64_tr_b16 v[164:165], v20 offset:0
  ds_read_b64_tr_b16 v[180:181], v21 offset:0
  ds_read_b64_tr_b16 v[166:167], v20 offset:4096
  ds_read_b64_tr_b16 v[182:183], v21 offset:4096
  ds_read_b64_tr_b16 v[168:169], v20 offset:8192
  ds_read_b64_tr_b16 v[184:185], v21 offset:8192
  ds_read_b64_tr_b16 v[170:171], v20 offset:12288
  ds_read_b64_tr_b16 v[186:187], v21 offset:12288
  ds_read_b64_tr_b16 v[172:173], v20 offset:16384
  ds_read_b64_tr_b16 v[188:189], v21 offset:16384
  ds_read_b64_tr_b16 v[174:175], v20 offset:20480
  ds_read_b64_tr_b16 v[190:191], v21 offset:20480
  ds_read_b64_tr_b16 v[176:177], v20 offset:24576
  ds_read_b64_tr_b16 v[192:193], v21 offset:24576
  ds_read_b64_tr_b16 v[178:179], v20 offset:28672
  ds_read_b64_tr_b16 v[194:195], v21 offset:28672
  v_mfma_f32_16x16x32_bf16 v[40:43], v[104:107], v[44:47], 0
  v_mfma_f32_16x16x32_bf16 v[40:43], v[104:107], v[48:51], v[40:43]
  v_mfma_f32_16x16x32_bf16 v[40:43], v[104:107], v[52:55], v[40:43]
  v_mfma_f32_16x16x32_bf16 v[40:43], v[104:107], v[56:59], v[40:43]
  s_waitcnt lgkmcnt(0)
  v_readfirstlane_b32 s31, v125
  s_cmp_lt_u32 s31, 14
  s_cbranch_scc1 L_pv0
  v_mfma_f32_16x16x32_bf16 v[32:35], v[164:167], v[44:47], 0
  v_mfma_f32_16x16x32_bf16 v[36:39], v[180:183], v[44:47], 0
  s_cmp_lt_u32 s31, 16
  s_cbranch_scc1 L_pv1
  v_mfma_f32_16x16x32_bf16 v[32:35], v[168:171], v[48:51], v[32:35]
  v_mfma_f32_16x16x32_bf16 v[36:39], v[184:187], v[48:51], v[36:39]
  s_cmp_lt_u32 s31, 18
  s_cbranch_scc1 L_pv2
  v_mfma_f32_16x16x32_bf16 v[32:35], v[172:175], v[52:55], v[32:35]
  v_mfma_f32_16x16x32_bf16 v[36:39], v[188:191], v[52:55], v[36:39]
  s_cmp_lt_u32 s31, 20
  s_cbranch_scc1 L_pv3
  v_mfma_f32_16x16x32_bf16 v[32:35], v[176:179], v[56:59], v[32:35]
  v_mfma_f32_16x16x32_bf16 v[36:39], v[192:195], v[56:59], v[36:39]
  s_nop 4
L_pvdone:
  s_mov_b64 exec, s[56:57]
  s_cmp_eq_u32 s58, 0
  v_bfi_b32 v32, s44, v122, v32
  v_bfi_b32 v33, s44, v122, v33
  v_bfi_b32 v34, s44, v112, v34
  v_bfi_b32 v35, s44, v112, v35
  v_bfi_b32 v36, s44, v122, v36
  v_bfi_b32 v37, s44, v122, v37
  v_bfi_b32 v38, s44, v112, v38
  v_bfi_b32 v39, s44, v112, v39
  v_bfi_b32 v61, s44, v122, v40
  s_cbranch_scc1 L_og
  global_store_dwordx4 v109, v[32:35], s[26:27]
  global_store_dwordx4 v109, v[36:39], s[26:27] offset:64
  s_mov_b64 exec, s[50:51]
  global_store_dwordx4 v110, v[60:63], s[26:27]
L_od:
  s_mov_b64 exec, -1
LP_17:
  ds_read_b32 v2, v127 offset:20
  s_sub_u32 s59, s59, 1
  s_cmp_lt_i32 s59, 0
  s_cbranch_scc1 LD_18
  s_waitcnt lgkmcnt(0)
  v_cmp_gt_u32 vcc, 24, v2
  s_cbranch_vccnz LP_17
LD_18:
  s_waitcnt lgkmcnt(0)
  ds_read_b64_tr_b16 v[64:65], v22 offset:0
  ds_read_b64_tr_b16 v[72:73], v23 offset:0
  ds_read_b64_tr_b16 v[66:67], v22 offset:4096
  ds_read_b64_tr_b16 v[74:75], v23 offset:4096
  ds_read_b64_tr_b16 v[68:69], v22 offset:8192
  ds_read_b64_tr_b16 v[76:77], v23 offset:8192
  ds_read_b64_tr_b16 v[70:71], v22 offset:12288
  ds_read_b64_tr_b16 v[78:79], v23 offset:12288
LP_19:
  ds_read_b32 v2, v127 offset:20
  s_sub_u32 s59, s59, 1
  s_cmp_lt_i32 s59, 0
  s_cbranch_scc1 LD_20
  s_waitcnt lgkmcnt(0)
  v_cmp_gt_u32 vcc, 26, v2
  s_cbranch_vccnz LP_19
LD_20:
  s_waitcnt lgkmcnt(0)
L_oround:
  global_load_dwordx4 v[48:51], v17, s[26:27] offset:0 sc1
  global_load_dwordx4 v[52:55], v18, s[26:27] offset:0 sc1
  global_load_dwordx4 v[40:43], v19, s[26:27] offset:0 sc1
  global_load_dwordx4 v[44:47], v19, s[26:27] offset:256 sc1
  s_waitcnt vmcnt(0)
  v_bitop3_b32 v116, v48, v49, v122 bitop3:0x7e
  v_bitop3_b32 v117, v50, v51, v112 bitop3:0x7e
  v_bitop3_b32 v118, v52, v53, v122 bitop3:0x7e
  v_bitop3_b32 v119, v54, v55, v112 bitop3:0x7e
  v_or3_b32 v116, v116, v117, v118
  v_bitop3_b32 v117, v40, v41, v122 bitop3:0x7e
  v_bitop3_b32 v118, v42, v43, v112 bitop3:0x7e
  v_or3_b32 v116, v116, v119, v117
  v_bitop3_b32 v117, v44, v45, v122 bitop3:0x7e
  v_bitop3_b32 v119, v46, v47, v112 bitop3:0x7e
  v_or3_b32 v116, v116, v118, v117
  v_bitop3_b32 v116, v116, v119, s44 bitop3:0xa8
  v_cmp_ne_u32 vcc, 0, v116
  s_cbranch_vccnz L_oretry
  s_mov_b64 exec, -1
L_ogot:
  v_and_b32 v40, s45, v40
  v_and_b32 v44, s45, v44
  v_max_f32 v56, v40, v44
  v_and_b32 v41, s45, v41
  v_and_b32 v45, s45, v45
  v_max_f32_dpp v56, v56, v56 row_ror:4 row_mask:0xf bank_mask:0xf
  v_and_b32 v48, s45, v48
  v_and_b32 v49, s45, v49
  v_max_f32_dpp v56, v56, v56 row_ror:8 row_mask:0xf bank_mask:0xf
  v_and_b32 v50, s45, v50
  v_and_b32 v51, s45, v51
  v_max_f32_dpp v56, v56, v56 row_bcast:15 row_mask:0xa bank_mask:0xf
  v_and_b32 v52, s45, v52
  v_and_b32 v53, s45, v53
  v_max_f32_dpp v56, v56, v56 row_bcast:31 row_mask:0xc bank_mask:0xf
  v_and_b32 v54, s45, v54
  v_readlane_b32 s41, v56, 63
  v_and_b32 v55, s45, v55
  s_nop 0
  v_subrev_f32 v40, s41, v40
  v_subrev_f32 v44, s41, v44
  v_mul_f32 v40, s48, v40
  v_mul_f32 v44, s48, v44
  v_exp_f32 v40, v40
  v_exp_f32 v44, v44
  s_nop 0
  v_mul_f32 v41, v41, v40
  v_fmac_f32 v41, v45, v44
  v_mul_f32 v48, v48, v40
  v_mul_f32 v49, v49, v40
  v_mul_f32 v50, v50, v40
  v_mul_f32 v51, v51, v40
  v_add_f32_dpp v41, v41, v41 row_ror:4 row_mask:0xf bank_mask:0xf
  v_fmac_f32 v48, v52, v44
  v_fmac_f32 v49, v53, v44
  v_add_f32_dpp v41, v41, v41 row_ror:8 row_mask:0xf bank_mask:0xf
  v_fmac_f32 v50, v54, v44
  v_fmac_f32 v51, v55, v44
  v_add_f32_dpp v41, v41, v41 row_bcast:15 row_mask:0xa bank_mask:0xf
  s_nop 0
  v_permlane32_swap_b32 v48, v49
  v_add_f32_dpp v41, v41, v41 row_bcast:31 row_mask:0xc bank_mask:0xf
  v_permlane32_swap_b32 v50, v51
  v_add_f32 v48, v48, v49
  v_readlane_b32 s42, v41, 63
  v_add_f32 v50, v50, v51
  s_nop 1
  v_permlane16_swap_b32 v48, v50
  v_rcp_f32 v41, s42
  v_add_f32 v48, v48, v50
  s_nop 1
  v_add_f32_dpp v48, v48, v48 row_ror:4 row_mask:0xf bank_mask:0xf
  s_nop 1
  v_add_f32_dpp v48, v48, v48 row_ror:8 row_mask:0xf bank_mask:0xf
  v_mul_f32 v48, v48, v41
  v_cvt_pk_bf16_f32 v48, v48, v48
  ds_write_b16 v96, v48
  s_waitcnt lgkmcnt(0)
  s_barrier
  ds_read2_b64 v[40:43], v97 offset0:0 offset1:4
  ds_read2_b64 v[44:47], v97 offset0:8 offset1:12
  ds_read_b32 v48, v121
L_wook:
  s_waitcnt lgkmcnt(0)
  v_mfma_f32_16x16x32_bf16 v[32:35], v[64:67], v[40:43], 0
  v_mfma_f32_16x16x32_bf16 v[36:39], v[72:75], v[40:43], 0
  v_mfma_f32_16x16x32_bf16 v[32:35], v[68:71], v[44:47], v[32:35]
  v_mfma_f32_16x16x32_bf16 v[36:39], v[76:79], v[44:47], v[36:39]
  s_mov_b32 vcc_lo, 0xaaaaaaaa
  s_mov_b32 vcc_hi, 0xaaaaaaaa
  v_mov_b32 v51, v122
  v_lshlrev_b32 v113, 16, v113
  s_nop 2
  v_cndmask_b32 v32, v32, v33, s[100:101]
  v_cndmask_b32 v34, v34, v35, s[100:101]
  v_cndmask_b32 v36, v36, v37, s[100:101]
  v_cndmask_b32 v38, v38, v39, s[100:101]
  v_cndmask_b32 v32, v32, v34, s[36:37]
  v_cndmask_b32 v36, v36, v38, s[36:37]
  v_cndmask_b32 v32, v32, v36, s[38:39]
  v_cndmask_b32 v50, v32, v48, vcc
  v_mul_f32 v52, v50, v100
  v_cmp_nlt_f32 vcc, abs(v52), s98
  v_cmp_ge_f32 s[60:61], abs(v52), s99
  v_med3_f32 v52, v52, s98, -s98
  v_cvt_f64_f32 v[52:53], v52
  v_cndmask_b32 v54, 0, v102, vcc
  v_add_f64 v[52:53], v[52:53], s[96:97]
  v_cndmask_b32 v55, 1, v103, s[60:61]
  v_lshlrev_b64 v[52:53], 14, v[52:53]
  v_or_b32 v52, v55, v52
  v_add_u32 v53, v53, v54
  global_atomic_add_x2 v[56:57], v98, v[52:53], s[26:27] sc0 sc1
  global_store_dwordx2 v111, v[50:51], s[26:27] sc1
  s_mov_b32 s62, 0x55555555
  s_mov_b32 s63, s62
  s_waitcnt vmcnt(1)
  v_add_co_u32 v56, vcc, v56, v52
  v_and_b32 v58, 0x7f, v56
  v_and_b32 v59, 0x3f80, v56
  v_addc_co_u32 v57, vcc, v57, v53, vcc
  v_cmp_eq_u32 vcc, 64, v58
  s_and_b64 s[94:95], vcc, s[62:63]
  s_cbranch_scc0 L_wend
  s_mov_b64 s[60:61], vcc
  v_ashrrev_i32 v58, 24, v57
  v_ashrrev_i64 v[56:57], 14, v[56:57]
  v_add_u32 v58, 1, v58
  v_add_u32 v57, 0x43380000, v57
  v_cmp_gt_u32 vcc, 2, v58
  v_add_f64 v[56:57], v[56:57], -s[96:97]
  s_and_b64 s[62:63], vcc, s[60:61]
  v_cmp_ne_u32 vcc, 0, v59
  v_cvt_f32_f64 v56, v[56:57]
  v_mul_f32 v56, v56, v101
  s_and_b64 s[62:63], s[62:63], vcc
  s_lshr_b64 s[60:61], s[62:63], 1
  s_and_b64 s[62:63], s[62:63], s[60:61]
  s_andn2_b64 s[62:63], s[94:95], s[62:63]
  s_cbranch_scc1 L_exact
L_fin:
  v_cvt_pk_bf16_f32 v56, v56, v56
  v_and_b32 v56, s40, v56
  s_nop 1
  v_mov_b32_dpp v57, v56 quad_perm:[1,0,3,2] row_mask:0xf bank_mask:0xf
  v_mul_f32 v58, 0xbfb8aa3b, v57
  v_exp_f32 v58, v58
  s_nop 0
  v_add_f32 v58, 1.0, v58
  v_rcp_f32 v58, v58
  s_nop 0
  v_mul_f32 v57, v57, v58
  v_cvt_pk_bf16_f32 v57, v57, v57
  v_and_b32 v57, s40, v57
  v_mul_f32 v56, v56, v57
  v_cvt_pk_bf16_f32 v56, v56, v56
  v_and_b32 v56, s40, v56
  v_add_f32 v56, v56, v113
  v_cvt_pk_bf16_f32 v56, v56, v56
  s_mov_b64 exec, s[94:95]
  global_store_short v115, v56, s[22:23]
  s_and_b32 s31, s94, 1
  s_xor_b32 s31, s31, 1
  s_or_b32 s31, s31, s43
  s_cbranch_scc1 L_wend
  s_mov_b64 exec, 1
  global_store_dword v13, v122, s[26:27]
L_wend:
  s_endpgm
L_pv0:
LP_21:
  ds_read_b32 v2, v127 offset:20
  ds_read_b64_tr_b16 v[64:65], v20 offset:0
  ds_read_b64_tr_b16 v[68:69], v21 offset:0
  ds_read_b64_tr_b16 v[66:67], v20 offset:4096
  ds_read_b64_tr_b16 v[70:71], v21 offset:4096
  s_sub_u32 s59, s59, 1
  s_cmp_lt_i32 s59, 0
  s_cbranch_scc1 LD_22
  s_waitcnt lgkmcnt(0)
  v_cmp_gt_u32 vcc, 14, v2
  s_cbranch_vccnz LP_21
LD_22:
  s_waitcnt lgkmcnt(0)
  v_mfma_f32_16x16x32_bf16 v[32:35], v[64:67], v[44:47], 0
  v_mfma_f32_16x16x32_bf16 v[36:39], v[68:71], v[44:47], 0
L_pv1:
LP_23:
  ds_read_b32 v2, v127 offset:20
  ds_read_b64_tr_b16 v[64:65], v20 offset:8192
  ds_read_b64_tr_b16 v[68:69], v21 offset:8192
  ds_read_b64_tr_b16 v[66:67], v20 offset:12288
  ds_read_b64_tr_b16 v[70:71], v21 offset:12288
  s_sub_u32 s59, s59, 1
  s_cmp_lt_i32 s59, 0
  s_cbranch_scc1 LD_24
  s_waitcnt lgkmcnt(0)
  v_cmp_gt_u32 vcc, 16, v2
  s_cbranch_vccnz LP_23
LD_24:
  s_waitcnt lgkmcnt(0)
  v_mfma_f32_16x16x32_bf16 v[32:35], v[64:67], v[48:51], v[32:35]
  v_mfma_f32_16x16x32_bf16 v[36:39], v[68:71], v[48:51], v[36:39]
L_pv2:
LP_25:
  ds_read_b32 v2, v127 offset:20
  ds_read_b64_tr_b16 v[64:65], v20 offset:16384
  ds_read_b64_tr_b16 v[68:69], v21 offset:16384
  ds_read_b64_tr_b16 v[66:67], v20 offset:20480
  ds_read_b64_tr_b16 v[70:71], v21 offset:20480
  s_sub_u32 s59, s59, 1
  s_cmp_lt_i32 s59, 0
  s_cbranch_scc1 LD_26
  s_waitcnt lgkmcnt(0)
  v_cmp_gt_u32 vcc, 18, v2
  s_cbranch_vccnz LP_25
LD_26:
  s_waitcnt lgkmcnt(0)
  v_mfma_f32_16x16x32_bf16 v[32:35], v[64:67], v[52:55], v[32:35]
  v_mfma_f32_16x16x32_bf16 v[36:39], v[68:71], v[52:55], v[36:39]
L_pv3:
LP_27:
  ds_read_b32 v2, v127 offset:20
  ds_read_b64_tr_b16 v[64:65], v20 offset:24576
  ds_read_b64_tr_b16 v[68:69], v21 offset:24576
  ds_read_b64_tr_b16 v[66:67], v20 offset:28672
  ds_read_b64_tr_b16 v[70:71], v21 offset:28672
  s_sub_u32 s59, s59, 1
  s_cmp_lt_i32 s59, 0
  s_cbranch_scc1 LD_28
  s_waitcnt lgkmcnt(0)
  v_cmp_gt_u32 vcc, 20, v2
  s_cbranch_vccnz LP_27
LD_28:
  s_waitcnt lgkmcnt(0)
  v_mfma_f32_16x16x32_bf16 v[32:35], v[64:67], v[56:59], v[32:35]
  v_mfma_f32_16x16x32_bf16 v[36:39], v[68:71], v[56:59], v[36:39]
  s_nop 3
  s_branch L_pvdone
L_oretry:
  s_mov_b64 exec, vcc
  s_sub_u32 s59, s59, 16
  s_cmp_lt_i32 s59, 0
  s_cbranch_scc0 L_oround
  s_mov_b64 exec, -1
  s_branch L_ogot
L_exact:
  v_mov_b32 v56, 0
  s_mov_b32 s31, 4
  v_add_u32 v60, 4096, v99
L_ex1:
  global_load_dwordx2 v[64:65], v99, s[26:27] offset:0 sc1
  global_load_dwordx2 v[66:67], v99, s[26:27] offset:512 sc1
  global_load_dwordx2 v[68:69], v99, s[26:27] offset:1024 sc1
  global_load_dwordx2 v[70:71], v99, s[26:27] offset:1536 sc1
  global_load_dwordx2 v[72:73], v99, s[26:27] offset:2048 sc1
  global_load_dwordx2 v[74:75], v99, s[26:27] offset:2560 sc1
  global_load_dwordx2 v[76:77], v99, s[26:27] offset:3072 sc1
  global_load_dwordx2 v[78:79], v99, s[26:27] offset:3584 sc1
  global_load_dwordx2 v[80:81], v60, s[26:27] offset:0 sc1
  global_load_dwordx2 v[82:83], v60, s[26:27] offset:512 sc1
  global_load_dwordx2 v[84:85], v60, s[26:27] offset:1024 sc1
  global_load_dwordx2 v[86:87], v60, s[26:27] offset:1536 sc1
  global_load_dwordx2 v[88:89], v60, s[26:27] offset:2048 sc1
  global_load_dwordx2 v[90:91], v60, s[26:27] offset:2560 sc1
  global_load_dwordx2 v[92:93], v60, s[26:27] offset:3072 sc1
  global_load_dwordx2 v[94:95], v60, s[26:27] offset:3584 sc1
  s_sub_u32 s59, s59, 16
  s_cmp_lt_i32 s59, 0
  s_cbranch_scc1 L_fin
  s_waitcnt vmcnt(0)
  v_mov_b32 v58, 0
  v_bitop3_b32 v59, v65, v67, v122 bitop3:0x7e
  v_or_b32 v58, v58, v59
  v_bitop3_b32 v59, v69, v71, v122 bitop3:0x7e
  v_or_b32 v58, v58, v59
  v_bitop3_b32 v59, v73, v75, v122 bitop3:0x7e
  v_or_b32 v58, v58, v59
  v_bitop3_b32 v59, v77, v79, v122 bitop3:0x7e
  v_or_b32 v58, v58, v59
  v_bitop3_b32 v59, v81, v83, v122 bitop3:0x7e
  v_or_b32 v58, v58, v59
  v_bitop3_b32 v59, v85, v87, v122 bitop3:0x7e
  v_or_b32 v58, v58, v59
  v_bitop3_b32 v59, v89, v91, v122 bitop3:0x7e
  v_or_b32 v58, v58, v59
  v_bitop3_b32 v59, v93, v95, v122 bitop3:0x7e
  v_or_b32 v58, v58, v59
  v_cmp_ne_u32 vcc, 0, v58
  s_cbranch_vccnz L_ex1
  v_add_f32 v56, v56, v64
  v_add_f32 v56, v56, v66
  v_add_f32 v56, v56, v68
  v_add_f32 v56, v56, v70
  v_add_f32 v56, v56, v72
  v_add_f32 v56, v56, v74
  v_add_f32 v56, v56, v76
  v_add_f32 v56, v56, v78
  v_add_f32 v56, v56, v80
  v_add_f32 v56, v56, v82
  v_add_f32 v56, v56, v84
  v_add_f32 v56, v56, v86
  v_add_f32 v56, v56, v88
  v_add_f32 v56, v56, v90
  v_add_f32 v56, v56, v92
  v_add_f32 v56, v56, v94
  v_add_u32 v99, 8192, v99
  v_add_u32 v60, 8192, v60
  s_sub_u32 s31, s31, 1
  s_cmp_lg_u32 s31, 0
  s_cbranch_scc1 L_ex1
  s_branch L_fin
L_qnl:
  s_mov_b64 s[94:95], exec
  s_mov_b64 exec, s[54:55]
  v_add_u32 v116, 1048576, v108
  global_store_dwordx4 v116, v[196:199], s[26:27] sc1
  s_cmp_lg_u32 s28, 0
  s_cbranch_scc1 QG_29
  s_mov_b64 exec, 1
  s_getreg_b32 s31, hwreg(HW_REG_XCC_ID, 0, 4)
  s_lshl_b32 s31, s31, 8
  v_mov_b32 v116, s31
  s_lshl_b32 s31, s30, 4
  s_add_u32 s31, s31, s49
  s_add_u32 s31, s31, 1048576
  v_bfi_b32 v116, s44, v122, v116
  v_mov_b32 v120, s31
  v_mov_b32 v117, v116
  v_mov_b32 v118, v112
  v_mov_b32 v119, v112
  global_store_dwordx4 v120, v[116:119], s[26:27] sc1
QG_29:
  s_waitcnt vmcnt(0)
  s_mov_b64 exec, s[94:95]
  s_branch L_qnld
L_kslow:
LP_30:
  ds_read_b32 v2, v127 offset:20
  s_sub_u32 s59, s59, 1
  s_cmp_lt_i32 s59, 0
  s_cbranch_scc1 LD_31
  s_waitcnt lgkmcnt(0)
  v_cmp_gt_u32 vcc, 12, v2
  s_cbranch_vccnz LP_30
LD_31:
  s_waitcnt lgkmcnt(0)
  ds_read_b128 v[64:67], v24 offset:0
  ds_read_b128 v[80:83], v24 offset:4096
  ds_read_b128 v[68:71], v25 offset:0
  ds_read_b128 v[84:87], v25 offset:4096
  ds_read_b128 v[72:75], v26 offset:0
  ds_read_b128 v[88:91], v26 offset:4096
  ds_read_b128 v[76:79], v27 offset:0
  ds_read_b128 v[92:95], v27 offset:4096
  s_waitcnt lgkmcnt(0)
  s_branch L_kok
L_woslow:
  s_branch L_wook
L_og:
  s_mov_b64 exec, -1
  v_add_u32 v109, 1048576, v109
  v_add_u32 v110, 1048576, v110
  v_add_u32 v17, 1048576, v17
  v_add_u32 v18, 1048576, v18
  v_add_u32 v19, 1048576, v19
  s_mov_b64 exec, s[56:57]
  global_store_dwordx4 v109, v[32:35], s[26:27] sc1
  global_store_dwordx4 v109, v[36:39], s[26:27] offset:64 sc1
  s_mov_b64 exec, s[50:51]
  global_store_dwordx4 v110, v[60:63], s[26:27] sc1
  s_branch L_od
L_fmain:
  s_cmp_ge_u32 s30, 28
  s_cbranch_scc1 L_fskip
  s_and_b32 s31, s30, 3
  s_lshl_b32 s31, s31, 8
  s_add_u32 s31, s31, 122880
  v_lshl_add_u32 v12, v5, 3, s31
  ds_read2_b64 v[32:35], v12 offset0:0 offset1:4
  ds_read2_b64 v[36:39], v12 offset0:8 offset1:12
  ds_read2_b64 v[40:43], v12 offset0:16 offset1:20
  ds_read2_b64 v[44:47], v12 offset0:24 offset1:28
  s_lshl_b32 s31, s53, 1
  v_lshrrev_b32 v16, 1, v14
  v_and_b32 v16, 3, v16
  v_xor_b32 v16, s31, v16
  v_lshlrev_b32 v16, 5, v16
  v_lshl_add_u32 v16, v14, 7, v16
  v_lshl_add_u32 v16, v15, 3, v16
  v_add_u32 v16, 16384, v16
  v_xor_b32 v17, 32, v16
  v_mov_b32 v18, v108
  s_nop 0
LP_32:
  s_sleep 1
  ds_read_b32 v2, v127 offset:20
  s_sub_u32 s59, s59, 1
  s_cmp_lt_i32 s59, 0
  s_cbranch_scc1 LD_33
  s_waitcnt lgkmcnt(0)
  v_cmp_gt_u32 vcc, 4, v2
  s_cbranch_vccnz LP_32
LD_33:
  s_waitcnt lgkmcnt(0)
  ds_read_b64_tr_b16 v[48:49], v16 offset:0
  ds_read_b64_tr_b16 v[50:51], v16 offset:2048
  ds_read_b64_tr_b16 v[52:53], v16 offset:4096
  ds_read_b64_tr_b16 v[54:55], v16 offset:6144
  ds_read_b64_tr_b16 v[56:57], v16 offset:8192
  ds_read_b64_tr_b16 v[58:59], v16 offset:10240
  ds_read_b64_tr_b16 v[60:61], v16 offset:12288
  ds_read_b64_tr_b16 v[62:63], v16 offset:14336
  ds_read_b64_tr_b16 v[64:65], v17 offset:0
  ds_read_b64_tr_b16 v[66:67], v17 offset:2048
  ds_read_b64_tr_b16 v[68:69], v17 offset:4096
  ds_read_b64_tr_b16 v[70:71], v17 offset:6144
  ds_read_b64_tr_b16 v[72:73], v17 offset:8192
  ds_read_b64_tr_b16 v[74:75], v17 offset:10240
  ds_read_b64_tr_b16 v[76:77], v17 offset:12288
  ds_read_b64_tr_b16 v[78:79], v17 offset:14336
  s_waitcnt lgkmcnt(0)
  v_mfma_f32_16x16x32_bf16 v[20:23], v[48:51], v[32:35], 0
  v_mfma_f32_16x16x32_bf16 v[24:27], v[64:67], v[32:35], 0
  v_mfma_f32_16x16x32_bf16 v[20:23], v[52:55], v[36:39], v[20:23]
  v_mfma_f32_16x16x32_bf16 v[24:27], v[68:71], v[36:39], v[24:27]
  v_mfma_f32_16x16x32_bf16 v[20:23], v[56:59], v[40:43], v[20:23]
  v_mfma_f32_16x16x32_bf16 v[24:27], v[72:75], v[40:43], v[24:27]
  v_mfma_f32_16x16x32_bf16 v[20:23], v[60:63], v[44:47], v[20:23]
  v_mfma_f32_16x16x32_bf16 v[24:27], v[76:79], v[44:47], v[24:27]
  v_and_b32 v29, 7, v1
  v_lshlrev_b32 v28, 8, v4
  v_lshl_add_u32 v28, v29, 4, v28
  s_lshr_b32 s47, s93, 2
  s_lshl_b32 s31, s47, 7
  s_add_u32 s31, s31, s46
  v_add_u32 v28, s31, v28
  s_nop 1
  v_add_u32 v20, 0x80, v20
  v_add_u32 v21, 0x80, v21
  v_add_u32 v22, 0x80, v22
  v_add_u32 v23, 0x80, v23
  v_bfi_b32 v20, s44, v122, v20
  v_bfi_b32 v21, s44, v122, v21
  v_bfi_b32 v22, s44, v112, v22
  v_bfi_b32 v23, s44, v112, v23
  v_add_u32 v24, 0x80, v24
  v_add_u32 v25, 0x80, v25
  v_add_u32 v26, 0x80, v26
  v_add_u32 v27, 0x80, v27
  v_bfi_b32 v24, s44, v122, v24
  v_bfi_b32 v25, s44, v122, v25
  v_bfi_b32 v26, s44, v112, v26
  v_bfi_b32 v27, s44, v112, v27
  s_mov_b64 exec, s[54:55]
  s_cmp_lg_u32 s91, 0
  s_cbranch_scc1 L_gsh
  global_store_dwordx4 v18, v[20:23], s[26:27]
  global_store_dwordx4 v18, v[24:27], s[26:27] offset:64
  s_branch L_gsd
  L_gsh:
  global_store_dwordx4 v18, v[20:23], s[26:27] sc1
  global_store_dwordx4 v18, v[24:27], s[26:27] offset:64 sc1
  L_gsd:
  s_mov_b64 exec, -1
  v_lshl_add_u32 v29, v29, 2, v5
  v_lshlrev_b32 v29, 1, v29
  v_add_u32 v29, 129920, v29
  s_lshl_b32 s31, s53, 2
  v_and_b32 v16, 7, v14
  v_xor_b32 v16, s31, v16
  v_lshlrev_b32 v16, 5, v16
  v_lshl_add_u32 v16, v14, 8, v16
  v_lshl_add_u32 v16, v15, 3, v16
  v_add_u32 v16, 114688, v16
  v_xor_b32 v17, 32, v16
  v_xor_b32 v18, 64, v16
  v_xor_b32 v19, 0x60, v16
  v_lshlrev_b32 v31, 3, v5
  v_add_u32 v31, 129920, v31
  s_cmp_lg_u32 s53, 0
  s_cbranch_scc1 L_fverd
LP_34:
  s_sleep 1
  ds_read_b32 v2, v127 offset:20
  s_sub_u32 s59, s59, 1
  s_cmp_lt_i32 s59, 0
  s_cbranch_scc1 LD_35
  s_waitcnt lgkmcnt(0)
  v_cmp_gt_u32 vcc, 13, v2
  s_cbranch_vccnz LP_34
LD_35:
  s_waitcnt lgkmcnt(0)
  global_load_dwordx4 v[128:131], v28, s[26:27] sc1
LP_36:
  s_sleep 1
  ds_read_b32 v2, v127 offset:20
  s_sub_u32 s59, s59, 1
  s_cmp_lt_i32 s59, 0
  s_cbranch_scc1 LD_37
  s_waitcnt lgkmcnt(0)
  v_cmp_gt_u32 vcc, 16, v2
  s_cbranch_vccnz LP_36
LD_37:
  s_waitcnt lgkmcnt(0)
  global_load_dwordx4 v[132:135], v28, s[26:27] sc1
  s_waitcnt vmcnt(1)
  v_bitop3_b32 v116, v128, v129, v122 bitop3:0x7e
  v_bitop3_b32 v117, v130, v131, v112 bitop3:0x7e
  v_bitop3_b32 v116, v116, v117, s44 bitop3:0xa8
  v_cmp_ne_u32 vcc, 0, v116
  s_cbranch_vccnz L_hf0
  v_and_b32 v32, s45, v128
  v_and_b32 v33, s45, v129
  v_and_b32 v34, s45, v130
  v_and_b32 v35, s45, v131
  s_branch L_hok
L_hf0:
  s_waitcnt vmcnt(0)
  v_bitop3_b32 v116, v132, v133, v122 bitop3:0x7e
  v_bitop3_b32 v117, v134, v135, v112 bitop3:0x7e
  v_bitop3_b32 v116, v116, v117, s44 bitop3:0xa8
  v_cmp_ne_u32 vcc, 0, v116
  s_cbranch_vccnz L_hf1
  v_and_b32 v32, s45, v132
  v_and_b32 v33, s45, v133
  v_and_b32 v34, s45, v134
  v_and_b32 v35, s45, v135
  s_branch L_hok
L_hf1:
  s_mov_b32 s62, 0
GP_38:
  global_load_dwordx4 v[32:35], v28, s[26:27] offset:0 sc1
  s_add_u32 s62, s62, 1
  s_and_b32 s63, s62, 7
  s_cmp_lt_u32 s63, 7
  s_cselect_b32 s63, 0, 1048576
  s_sub_u32 s59, s59, 16
  s_cmp_lt_i32 s59, 0
  s_cbranch_scc1 GD_39
  s_or_b32 s63, s63, s91
  v_and_b32 v28, 1048575, v28
  v_or_b32 v28, s63, v28
  s_waitcnt vmcnt(0)
  s_cmp_eq_u32 s63, 0
  s_cbranch_scc1 GN_40
  s_mov_b64 s[94:95], exec
  s_mov_b64 exec, s[54:55]
  v_or_b32 v116, 1048576, v108
  global_store_dwordx4 v116, v[20:23], s[26:27] sc1
  global_store_dwordx4 v116, v[24:27], s[26:27] offset:64 sc1
  s_waitcnt vmcnt(0)
  s_mov_b64 exec, s[94:95]
GN_40:
  v_bitop3_b32 v116, v32, v33, v122 bitop3:0x7e
  v_bitop3_b32 v117, v34, v35, v112 bitop3:0x7e
  v_bitop3_b32 v118, v116, v117, s44 bitop3:0xa8
  v_cmp_ne_u32 vcc, 0, v118
  s_mov_b64 exec, vcc
  s_cbranch_execnz GP_38
GD_39:
  s_mov_b64 exec, -1
  s_waitcnt vmcnt(0)
  v_and_b32 v32, s45, v32
  v_and_b32 v33, s45, v33
  v_and_b32 v34, s45, v34
  v_and_b32 v35, s45, v35
L_hok:
  s_nop 0
  v_permlane16_swap_b32 v32, v33
  v_permlane16_swap_b32 v34, v35
  v_add_f32 v32, v32, v33
  v_add_f32 v34, v34, v35
  s_nop 0
  v_add_f32_dpp v32, v32, v32 row_ror:8 row_mask:0xf bank_mask:0xf
  v_add_f32_dpp v34, v34, v34 row_ror:8 row_mask:0xf bank_mask:0xf
  s_nop 1
  v_permlane32_swap_b32 v32, v34
  v_cvt_pk_bf16_f32 v32, v32, v32
  v_and_b32 v32, s40, v32
  v_cvt_pk_bf16_f32 v34, v34, v34
  v_and_b32 v34, s40, v34
  v_mul_f32 v33, 0xbfb8aa3b, v32
  v_exp_f32 v33, v33
  s_nop 0
  v_add_f32 v33, 1.0, v33
  v_rcp_f32 v33, v33
  s_nop 0
  v_mul_f32 v32, v32, v33
  v_cvt_pk_bf16_f32 v32, v32, v32
  v_and_b32 v32, s40, v32
  v_mul_f32 v32, v32, v34
  v_cvt_pk_bf16_f32 v32, v32, v32
  ds_write_b16 v29, v32
  ds_write_b8 v127, v126 offset:24
L_fverd:
LP_41:
  s_sleep 1
  ds_read_b32 v2, v127 offset:36
  s_sub_u32 s59, s59, 1
  s_cmp_lt_i32 s59, 0
  s_cbranch_scc1 LD_42
  s_waitcnt lgkmcnt(0)
  v_cmp_eq_u32 vcc, 0, v2
  s_cbranch_vccnz LP_41
LD_42:
  s_waitcnt lgkmcnt(0)
  v_cmp_ne_u32 vcc, 2, v2
  s_cbranch_vccnz L_fdown
  s_mov_b64 s[94:95], exec
  s_mov_b64 exec, s[54:55]
  v_or_b32 v116, 1048576, v108
  global_store_dwordx4 v116, v[20:23], s[26:27] sc1
  global_store_dwordx4 v116, v[24:27], s[26:27] offset:64 sc1
  s_waitcnt vmcnt(0)
  s_mov_b64 exec, s[94:95]
L_fdown:
  s_cmp_eq_u32 s53, 0
  s_cbranch_scc1 L_zfa
  s_and_b32 s31, s30, 3
  s_lshl_b32 s31, s31, 6
  s_add_u32 s31, s31, 122880
  v_and_b32 v36, 3, v1
  v_lshl_add_u32 v36, v36, 4, s31
LP_43:
  s_sleep 1
  ds_read_b32 v2, v127 offset:20
  s_sub_u32 s59, s59, 1
  s_cmp_lt_i32 s59, 0
  s_cbranch_scc1 LD_44
  s_waitcnt lgkmcnt(0)
  v_cmp_gt_u32 vcc, 10, v2
  s_cbranch_vccnz LP_43
LD_44:
  s_waitcnt lgkmcnt(0)
  s_branch GP_45
GS_47:
  s_sleep 4
GP_45:
  global_load_dwordx4 v[32:35], v36, s[26:27] offset:0 sc1
  s_sub_u32 s59, s59, 16
  s_cmp_lt_i32 s59, 0
  s_cbranch_scc1 GD_46
  s_waitcnt vmcnt(0)
  v_bitop3_b32 v116, v32, v33, v122 bitop3:0x7e
  v_bitop3_b32 v117, v34, v35, v112 bitop3:0x7e
  v_bitop3_b32 v118, v116, v117, s44 bitop3:0xa8
  v_cmp_ne_u32 vcc, 0, v118
  s_mov_b64 exec, vcc
  s_cbranch_execnz GS_47
GD_46:
  s_mov_b64 exec, -1
  s_waitcnt vmcnt(0)
L_zfa:
LP_48:
  s_sleep 1
  ds_read2_b32 v[124:125], v127 offset0:6 offset1:5
  s_sub_u32 s59, s59, 1
  s_cmp_lt_i32 s59, 0
  s_cbranch_scc1 LD_49
  s_waitcnt lgkmcnt(0)
  v_cmp_ne_u32 vcc, 1, v124
  s_mov_b64 s[60:61], vcc
  v_cmp_gt_u32 vcc, 26, v125
  s_or_b64 vcc, vcc, s[60:61]
  s_cbranch_scc1 LP_48
LD_49:
  s_waitcnt lgkmcnt(0)
  ds_read2_b64 v[40:43], v31 offset0:0 offset1:4
  ds_read_b64_tr_b16 v[48:49], v16 offset:0
  ds_read_b64_tr_b16 v[50:51], v16 offset:4096
  ds_read_b64_tr_b16 v[52:53], v17 offset:0
  ds_read_b64_tr_b16 v[54:55], v17 offset:4096
  ds_read_b64_tr_b16 v[56:57], v18 offset:0
  ds_read_b64_tr_b16 v[58:59], v18 offset:4096
  ds_read_b64_tr_b16 v[60:61], v19 offset:0
  ds_read_b64_tr_b16 v[62:63], v19 offset:4096
  s_waitcnt lgkmcnt(0)
  v_mfma_f32_16x16x32_bf16 v[64:67], v[40:43], v[48:51], 0
  v_mfma_f32_16x16x32_bf16 v[68:71], v[40:43], v[52:55], 0
  v_mfma_f32_16x16x32_bf16 v[72:75], v[40:43], v[56:59], 0
  v_mfma_f32_16x16x32_bf16 v[76:79], v[40:43], v[60:63], 0
  s_nop 4
  s_branch L_fb
L_fskip:
  s_waitcnt vmcnt(0)
  s_cmp_ge_u32 s47, 16
  s_cbranch_scc1 L_noz2
  s_lshl_b32 s34, s47, 4
  s_add_u32 s34, s34, 122880
  v_mov_b32 v16, s34
  v_mov_b32 v20, v122
  v_mov_b32 v21, v122
  v_mov_b32 v22, v112
  v_mov_b32 v23, v112
  s_mov_b64 exec, 1
  global_store_dwordx4 v16, v[20:23], s[26:27] sc1
  s_mov_b64 exec, -1
  L_noz2:
  v_mov_b32 v64, 0
  v_mov_b32 v68, 0
  v_mov_b32 v72, 0
  v_mov_b32 v76, 0
  s_cmp_eq_u32 s53, 0
  s_cbranch_scc1 L_zfb
  s_and_b32 s31, s30, 3
  s_lshl_b32 s31, s31, 6
  s_add_u32 s31, s31, 122880
  v_and_b32 v36, 3, v1
  v_lshl_add_u32 v36, v36, 4, s31
LP_50:
  s_sleep 1
  ds_read_b32 v2, v127 offset:20
  s_sub_u32 s59, s59, 1
  s_cmp_lt_i32 s59, 0
  s_cbranch_scc1 LD_51
  s_waitcnt lgkmcnt(0)
  v_cmp_gt_u32 vcc, 10, v2
  s_cbranch_vccnz LP_50
LD_51:
  s_waitcnt lgkmcnt(0)
  s_branch GP_52
GS_54:
  s_sleep 4
GP_52:
  global_load_dwordx4 v[32:35], v36, s[26:27] offset:0 sc1
  s_sub_u32 s59, s59, 16
  s_cmp_lt_i32 s59, 0
  s_cbranch_scc1 GD_53
  s_waitcnt vmcnt(0)
  v_bitop3_b32 v116, v32, v33, v122 bitop3:0x7e
  v_bitop3_b32 v117, v34, v35, v112 bitop3:0x7e
  v_bitop3_b32 v118, v116, v117, s44 bitop3:0xa8
  v_cmp_ne_u32 vcc, 0, v118
  s_mov_b64 exec, vcc
  s_cbranch_execnz GS_54
GD_53:
  s_mov_b64 exec, -1
  s_waitcnt vmcnt(0)
L_zfb:
L_fb:
  s_lshl_b32 s31, s53, 8
  s_add_u32 s31, s31, 130304
  v_lshl_add_u32 v12, v6, 2, s31
  ds_write_b32 v12, v64 offset:0
  ds_write_b32 v12, v68 offset:64
  ds_write_b32 v12, v72 offset:128
  ds_write_b32 v12, v76 offset:192
  s_waitcnt lgkmcnt(0)
L_fend:
  s_endpgm
L_end:
  s_endpgm
L_codeend:
.section .rodata,"a"
.p2align 6
.amdhsa_kernel recurrent_scan__sliding_block_cached__swiglu_ffn__decode_kernel
  .amdhsa_next_free_vgpr 200
  .amdhsa_next_free_sgpr 102
  .amdhsa_accum_offset 200
  .amdhsa_group_segment_fixed_size 0
  .amdhsa_kernarg_size 96
  .amdhsa_user_sgpr_count 2
  .amdhsa_user_sgpr_kernarg_segment_ptr 1
  .amdhsa_system_sgpr_workgroup_id_x 1
  .amdhsa_float_denorm_mode_32 3
.end_amdhsa_kernel
```
